```python
import torch

def _softmax(x, axis=-1):
    return torch.softmax(x, dim=axis)
def _gelu(x):
    return torch.nn.functional.gelu(x, approximate="tanh")
def _silu(x):
    return torch.nn.functional.silu(x)
def _sigmoid(x):
    return torch.sigmoid(x)
def _layernorm(x, axis=-1, eps=1e-5):
    m = x.mean(dim=axis, keepdim=True)
    v = x.var(dim=axis, keepdim=True, unbiased=False)
    return (x - m) / torch.sqrt(v + eps)
def _scatter_add(tgt, idx, src, axis=0):
    return tgt.clone().index_add_(axis, idx, src)
def _segment_sum(src, seg, n):
    out = torch.zeros((n,) + src.shape[1:], dtype=src.dtype)
    return out.index_add_(0, seg, src)
def _pad(x, pw):
    flat = tuple(v for pair in reversed(pw) for v in pair)
    return torch.nn.functional.pad(x, flat)

kernel_name = 'standalone__mha_block_cached__near_ridge'

def setup_inputs():

    _w = (lambda a: (lambda t: t.to(torch.bfloat16) if t.is_floating_point() else t)(torch.as_tensor(a)))
    B, Sq, D = 8, 80, 1024
    H, Sk, Dh = 32, 80, 128
    return {
        "x": _w((lambda *s: torch.randn(*s, dtype=torch.bfloat16) * 0.8)(B, Sq, D)),
        "k_cache": _w((lambda *s: torch.randn(*s, dtype=torch.bfloat16) * 0.8)(B, H, Sk, Dh)),
        "v_cache": _w((lambda *s: torch.randn(*s, dtype=torch.bfloat16) * 0.05)(B, H, Sk, Dh)),
        "wq": _w((lambda *s: torch.randn(*s, dtype=torch.bfloat16) * 0.8)(D, H * Dh) * (D ** -0.5)),
        "wo": _w((lambda *s: torch.randn(*s, dtype=torch.bfloat16) * 0.05)(H * Dh, D) * ((H * Dh) ** -0.5)),
    }

def reference(x, k_cache, v_cache, wq, wo):
    B, Sq, D = x.shape
    H, Dh = 32, 128
    q = (lambda x, *d: x.permute(*d))((x @ wq).reshape(B, Sq, H, Dh), 0, 2, 1, 3)
    scores = torch.einsum("bhqd,bhkd->bhqk", q, k_cache) * (Dh ** -0.5)
    p = _softmax(scores, axis=-1)
    o = torch.einsum("bhqk,bhkd->bhqd", p, v_cache)
    return (lambda x, *d: x.permute(*d))(o, 0, 2, 1, 3).reshape(B, Sq, H * Dh) @ wo
```

```asm
; @launch grid=(256,1,1) block=(512,1,1) lds=163840
.amdgcn_target "amdgcn-amd-amdhsa--gfx950"
.text
.globl standalone__mha_block_cached__near_ridge_kernel
.p2align 8
.type standalone__mha_block_cached__near_ridge_kernel,@function
standalone__mha_block_cached__near_ridge_kernel:
    s_cmp_ge_u32 s2, 256
    s_cbranch_scc1 L_end
    s_load_dwordx16 s[4:19], s[0:1], 0
    v_lshrrev_b32 v6, 6, v0
    v_and_b32 v1, 63, v0
    v_readfirstlane_b32 s64, v6
    s_getpc_b64 s[20:21]
L_pc:
    s_sub_u32 s20, s20, L_pc-standalone__mha_block_cached__near_ridge_kernel
    s_subb_u32 s21, s21, 0
    s_mov_b32 s22, L_end-standalone__mha_block_cached__near_ridge_kernel
    s_mov_b32 s23, 0x20000
    v_lshlrev_b32 v14, 6, v1
    s_and_b32 s74, s2, 0xf8
    s_add_u32 s74, s74, s64
    s_lshl_b32 s74, s74, 7
    s_mov_b64 exec, 3
    buffer_load_dword v127, v14, s[20:23], s74 offen
    s_mov_b64 exec, -1
    v_and_b32 v2, 15, v0
    v_lshrrev_b32 v3, 4, v1
    v_lshlrev_b32 v4, 4, v1
    s_and_b32 s65, s2, 7
    s_bfe_u32 s66, s2, 0x20003
    s_lshr_b32 s67, s2, 5
    s_lshl_b32 s68, s65, 2
    s_add_u32 s68, s68, s66
    s_lshr_b32 s69, s65, 1
    s_and_b32 s70, s68, 7
    s_cmp_lt_u32 s64, 4
    s_cbranch_scc1 L_compute
    s_sub_u32 s81, s64, 4
    s_mul_i32 s74, s81, 20
    s_mul_i32 s86, s81, 2560
    v_lshrrev_b32 v6, 3, v1
    v_add_u32 v6, s74, v6
    v_and_b32 v7, 7, v1
    v_bfe_u32 v21, v6, 1, 3
    v_xor_b32 v21, v21, v7
    v_lshlrev_b32 v21, 4, v21
    v_lshl_add_u32 v8, v6, 11, v21
    v_add_u32 v9, 15360, v8
    v_add_u32 v10, 30720, v8
    v_xor_b32 v9, 64, v9
    s_lshl_b32 s74, s81, 4
    v_add_u32 v6, s74, v3
    v_lshlrev_b32 v21, 1, v3
    v_xor_b32 v21, v21, v2
    v_lshlrev_b32 v22, 4, v21
    v_lshl_add_u32 v11, v6, 13, v22
    v_add_u32 v13, 63488, v11
    v_add_u32 v12, 31744, v11
    v_xor_b32 v13, 0x80, v13
    v_add_u32 v14, 31744, v13
    s_lshl_b32 s87, s81, 12
    s_add_u32 s87, s87, 10240
    s_add_u32 s88, s67, s65
    s_lshl_b32 s88, s88, 1
    s_and_b32 s88, s88, 15
    s_mov_b32 s73, 26624
    s_and_b32 s91, s66, 0
    s_mul_i32 s74, s67, 163840
    s_lshl_b32 s75, s68, 8
    s_sub_u32 s76, 0x800000, s75
    s_add_u32 m0, s73, s86
    s_lshl_b32 s89, s88, 7
    s_lshl_b32 s90, s88, 19
    s_waitcnt lgkmcnt(0)
    s_add_u32 s20, s4, s74
    s_addc_u32 s21, s5, 0
    s_mov_b32 s22, 163840
    s_mov_b32 s23, 0x20000
    s_add_u32 s24, s10, s75
    s_addc_u32 s25, s11, 0
    s_mov_b32 s26, s76
    s_mov_b32 s27, 0x20000
    buffer_load_dwordx4 v8, s[20:23], s89 offen lds
    buffer_load_dwordx4 v9, s[20:23], s89 offen offset:1024 lds
    s_mov_b32 exec_hi, 0
    buffer_load_dwordx4 v10, s[20:23], s89 offen offset:2048 lds
    s_add_u32 m0, s73, s87
    s_mov_b32 exec_hi, -1
    buffer_load_dwordx4 v11, s[24:27], s90 offen offset:0 lds
    buffer_load_dwordx4 v12, s[24:27], s90 offen offset:1024 lds
    buffer_load_dwordx4 v13, s[24:27], s90 offen offset:2048 lds
    buffer_load_dwordx4 v14, s[24:27], s90 offen offset:3072 lds
    s_add_u32 s88, s88, 1
    s_and_b32 s88, s88, 15
    s_add_u32 s73, s73, 26624
    s_cmp_eq_u32 s73, 106496
    s_cselect_b32 s73, 0, s73
    s_add_u32 m0, s73, s86
    s_lshl_b32 s89, s88, 7
    s_lshl_b32 s90, s88, 19
    s_lshr_b32 s74, s2, 3
    s_and_b32 s75, s74, 7
    s_and_b32 s74, s74, 3
    s_min_u32 s76, s74, 2
    s_cmp_eq_u32 s64, 4
    s_cselect_b32 s76, s75, s76
    s_cselect_b64 s[98:99], s[18:19], s[6:7]
    s_cmp_eq_u32 s64, 5
    s_cselect_b32 s76, s74, s76
    s_cselect_b64 s[98:99], s[12:13], s[98:99]
    s_cmp_eq_u32 s64, 7
    s_cselect_b64 s[98:99], s[8:9], s[98:99]
    s_lshl_b32 s76, s76, 21
    s_load_dword s57, s[98:99], s76
    s_load_dword s58, s[14:15], 0
    s_lshl_b32 s74, s67, 5
    s_add_u32 s74, s74, s68
    s_mul_i32 s74, s74, 20480
    s_add_u32 s28, s6, s74
    s_addc_u32 s29, s7, 0
    s_mov_b32 s30, 20480
    s_mov_b32 s31, 0x20000
    s_add_u32 s32, s8, s74
    s_addc_u32 s33, s9, 0
    s_mov_b32 s34, 20480
    s_mov_b32 s35, 0x20000
    s_lshl_b32 s74, s69, 21
    s_lshl_b32 s75, s70, 8
    s_add_u32 s74, s74, s75
    s_sub_u32 s75, 0x800000, s74
    s_add_u32 s36, s12, s74
    s_addc_u32 s37, s13, 0
    s_mov_b32 s38, s75
    s_mov_b32 s39, 0x20000
    s_lshl_b32 s76, s67, 2
    s_add_u32 s76, s76, s69
    s_mul_i32 s74, s76, 163840
    s_add_u32 s40, s18, s74
    s_addc_u32 s41, s19, 0
    s_mov_b32 s42, 163840
    s_mov_b32 s43, 0x20000
    s_lshl_b32 s74, s76, 8
    s_add_u32 s74, s74, 5242880
    s_add_u32 s44, s18, s74
    s_addc_u32 s45, s19, 0
    s_mov_b32 s46, 256
    s_mov_b32 s47, 0x20000
    s_add_u32 s48, s18, 6291456
    s_addc_u32 s49, s19, 0
    s_mov_b32 s50, 7865344
    s_mov_b32 s51, 0x20000
    s_mov_b32 s52, s14
    s_mov_b32 s53, s15
    s_mov_b32 s54, 1310720
    s_mov_b32 s55, 0x20000
    s_movk_i32 s56, 0xff
    s_mul_i32 s94, s2, 30720
    s_lshl_b32 s83, s67, 1
    s_lshr_b32 s84, s64, 2
    s_and_b32 s85, s64, 3
    s_mov_b32 s82, 0x3e0293ee
    v_lshl_add_u32 v15, v3, 11, v22
    v_add_u32 v16, 7168, v15
    v_add_u32 v17, 14336, v15
    v_xor_b32 v16, 0x80, v16
    v_add_u32 v18, 14336, v16
    s_lshl_b32 s74, s85, 2
    v_add_u32 v20, s74, v3
    v_xor_b32 v21, v20, v2
    v_lshlrev_b32 v21, 4, v21
    v_lshl_add_u32 v6, v20, 8, v21
    v_and_b32 v21, 7, v20
    v_lshlrev_b32 v21, 1, v21
    v_xor_b32 v21, v21, v2
    v_lshlrev_b32 v21, 4, v21
    v_lshl_add_u32 v7, v20, 8, v21
    s_lshr_b32 s74, s2, 3
    s_and_b32 s74, s74, 7
    s_add_u32 s3, s74, 3
    s_add_u32 s71, s74, 3
    v_lshrrev_b32 v20, 1, v3
    v_xor_b32 v20, v20, v2
    v_lshlrev_b32 v20, 4, v20
    v_lshl_add_u32 v20, v2, 8, v20
    v_and_b32 v21, 1, v3
    v_lshl_add_u32 v20, v21, 3, v20
    v_add_u32 v113, 106496, v20
    v_xor_b32 v114, 32, v113
    v_xor_b32 v115, 64, v113
    v_xor_b32 v116, 96, v113
    v_xor_b32 v117, 128, v113
    v_xor_b32 v118, 160, v113
    v_xor_b32 v119, 192, v113
    v_xor_b32 v120, 224, v113
    s_lshl_b32 s74, s64, 12
    s_add_u32 s74, s74, 86016
    v_add_u32 v121, s74, v4
    v_mov_b32 v122, 0x3f803f80
    v_mov_b32 v123, 0x3f803f80
    v_mov_b32 v124, 0x3f803f80
    v_mov_b32 v125, 0x3f803f80
    v_bfe_u32 v20, v1, 2, 2
    v_and_b32 v21, 1, v3
    v_lshl_add_u32 v21, v21, 2, v20
    v_lshlrev_b32 v21, 1, v21
    v_bfe_u32 v22, v1, 1, 1
    v_xor_b32 v21, v21, v22
    v_lshl_add_u32 v20, v3, 2, v20
    v_lshlrev_b32 v20, 8, v20
    v_lshl_add_u32 v20, v21, 4, v20
    v_and_b32 v21, 1, v1
    v_lshl_add_u32 v112, v21, 3, v20
    s_mov_b32 s72, -2
L_lpro:
    buffer_load_dwordx4 v8, s[20:23], s89 offen lds
    buffer_load_dwordx4 v9, s[20:23], s89 offen offset:1024 lds
    s_mov_b32 exec_hi, 0
    buffer_load_dwordx4 v10, s[20:23], s89 offen offset:2048 lds
    s_add_u32 m0, s73, s87
    s_mov_b32 exec_hi, -1
    buffer_load_dwordx4 v11, s[24:27], s90 offen offset:0 lds
    buffer_load_dwordx4 v12, s[24:27], s90 offen offset:1024 lds
    buffer_load_dwordx4 v13, s[24:27], s90 offen offset:2048 lds
    buffer_load_dwordx4 v14, s[24:27], s90 offen offset:3072 lds
    s_add_u32 s88, s88, 1
    s_and_b32 s88, s88, 15
    s_add_u32 s73, s73, 26624
    s_cmp_eq_u32 s73, 106496
    s_cselect_b32 s73, 0, s73
    s_add_u32 m0, s73, s86
    s_lshl_b32 s89, s88, 7
    s_lshl_b32 s90, s88, 19
    s_add_u32 s72, s72, 1
    s_cmp_lg_u32 s72, 0
    s_cbranch_scc1 L_lpro
    s_waitcnt vmcnt(14)
L_lloop:
    s_barrier
    buffer_load_dwordx4 v8, s[20:23], s89 offen lds
    buffer_load_dwordx4 v9, s[20:23], s89 offen offset:1024 lds
    s_mov_b32 exec_hi, 0
    buffer_load_dwordx4 v10, s[20:23], s89 offen offset:2048 lds
    s_add_u32 m0, s73, s87
    s_mov_b32 exec_hi, -1
    buffer_load_dwordx4 v11, s[24:27], s90 offen offset:0 lds
    buffer_load_dwordx4 v12, s[24:27], s90 offen offset:1024 lds
    buffer_load_dwordx4 v13, s[24:27], s90 offen offset:2048 lds
    buffer_load_dwordx4 v14, s[24:27], s90 offen offset:3072 lds
    s_add_u32 s88, s88, 1
    s_and_b32 s88, s88, 15
    s_add_u32 s73, s73, 26624
    s_cmp_eq_u32 s73, 106496
    s_cselect_b32 s73, 0, s73
    s_add_u32 m0, s73, s86
    s_lshl_b32 s89, s88, 7
    s_lshl_b32 s90, s88, 19
    s_cmp_eq_u32 s72, s3
    s_cbranch_scc1 L_l_k
    s_add_u32 s72, s72, 1
    s_cmp_lt_u32 s72, 13
    s_waitcnt vmcnt(14)
L_l_next:
    s_cbranch_scc1 L_lloop
    s_barrier
    s_lshl_b32 s74, s85, 6
    s_lshl_b32 s75, s84, 13
    v_xor_b32 v98, s74, v112
    v_add_u32 v98, s75, v98
    v_xor_b32 v99, 32, v98
    v_add_u32 v100, 0x10000, v98
    v_add_u32 v102, 0x20000, v98
    v_add_u32 v101, 0x10000, v99
    v_add_u32 v103, 0x20000, v99
    s_lshl_b32 s74, s84, 14
    v_add_u32 v9, s74, v4
    s_lshl_b32 s90, s64, 12
    s_lshl_b32 s75, s85, 2
    s_sub_u32 s75, s75, s83
    s_add_u32 s75, s75, 0
    s_and_b32 s75, s75, 15
    s_lshl_b32 s75, s75, 10
    s_add_u32 s91, s75, s74
    s_lshl_b32 s75, s85, 2
    s_sub_u32 s75, s75, s83
    s_add_u32 s75, s75, 2
    s_and_b32 s75, s75, 15
    s_lshl_b32 s75, s75, 10
    s_add_u32 s92, s75, s74
    s_lshl_b32 s74, s85, 11
    s_add_u32 s74, s74, 147456
    v_add_u32 v10, s74, v4
    v_add_u32 v11, 8192, v10
    v_lshlrev_b32 v8, 11, v2
    v_and_b32 v6, 1, v3
    v_lshl_add_u32 v8, v6, 5, v8
    v_lshrrev_b32 v6, 1, v3
    v_lshl_add_u32 v8, v6, 4, v8
    v_add_u32 v6, 81920, v9
    v_add_u32 v7, 114688, v9
    s_lshl_b32 s74, s85, 9
    s_add_u32 s74, s74, 65536
    v_lshl_add_u32 v104, v1, 2, s74
    s_waitcnt vmcnt(7)
    s_waitcnt lgkmcnt(0)
    s_mov_b32 s58, 0x65104329
    s_mov_b32 s59, 0x10432987
    s_and_b32 s74, s64, 1
    s_lshl_b32 s86, s74, 13
    s_lshl_b32 s87, s74, 20
    s_bfe_u32 s72, s64, 0x10001
    s_barrier
L_wo1:
    s_lshl_b32 s74, s72, 2
    s_lshr_b64 s[76:77], s[58:59], s74
    s_and_b32 s76, s76, 15
    s_lshl_b32 s76, s76, 14
    s_add_u32 s76, s76, s86
    s_add_u32 s74, s72, s83
    s_and_b32 s74, s74, 15
    s_lshl_b32 s74, s74, 16
    s_mov_b32 m0, s76
    s_add_u32 s74, s74, s87
    buffer_load_dwordx4 v15, s[36:39], s74 offen offset:0 lds
    buffer_load_dwordx4 v16, s[36:39], s74 offen offset:1024 lds
    buffer_load_dwordx4 v17, s[36:39], s74 offen offset:2048 lds
    buffer_load_dwordx4 v18, s[36:39], s74 offen offset:3072 lds
    s_add_u32 m0, s76, 4096
    s_add_u32 s74, s74, 32768
    buffer_load_dwordx4 v15, s[36:39], s74 offen offset:0 lds
    buffer_load_dwordx4 v16, s[36:39], s74 offen offset:1024 lds
    buffer_load_dwordx4 v17, s[36:39], s74 offen offset:2048 lds
    buffer_load_dwordx4 v18, s[36:39], s74 offen offset:3072 lds
    s_waitcnt vmcnt(8)
    s_barrier
    s_cmp_lg_u32 s64, 4
    s_cbranch_scc1 L_l_noattn
    ds_read_b64 a[0:1], v113 offset:0
    ds_read_b64 a[2:3], v114 offset:0
    ds_read_b64 a[4:5], v115 offset:0
    ds_read_b64 a[6:7], v116 offset:0
    ds_read_b64 a[8:9], v117 offset:0
    ds_read_b64 a[10:11], v118 offset:0
    ds_read_b64 a[12:13], v119 offset:0
    ds_read_b64 a[14:15], v120 offset:0
    ds_read_b64 a[16:17], v113 offset:4096
    ds_read_b64 a[18:19], v114 offset:4096
    ds_read_b64 a[20:21], v115 offset:4096
    ds_read_b64 a[22:23], v116 offset:4096
    ds_read_b64 a[24:25], v117 offset:4096
    ds_read_b64 a[26:27], v118 offset:4096
    ds_read_b64 a[28:29], v119 offset:4096
    ds_read_b64 a[30:31], v120 offset:4096
    ds_read_b64 a[32:33], v113 offset:8192
    ds_read_b64 a[34:35], v114 offset:8192
    ds_read_b64 a[36:37], v115 offset:8192
    ds_read_b64 a[38:39], v116 offset:8192
    ds_read_b64 a[40:41], v117 offset:8192
    ds_read_b64 a[42:43], v118 offset:8192
    ds_read_b64 a[44:45], v119 offset:8192
    ds_read_b64 a[46:47], v120 offset:8192
    ds_read_b64 a[48:49], v113 offset:12288
    ds_read_b64 a[50:51], v114 offset:12288
    ds_read_b64 a[52:53], v115 offset:12288
    ds_read_b64 a[54:55], v116 offset:12288
    ds_read_b64 a[56:57], v117 offset:12288
    ds_read_b64 a[58:59], v118 offset:12288
    ds_read_b64 a[60:61], v119 offset:12288
    ds_read_b64 a[62:63], v120 offset:12288
    ds_read_b64 a[64:65], v113 offset:16384
    ds_read_b64 a[66:67], v114 offset:16384
    ds_read_b64 a[68:69], v115 offset:16384
    ds_read_b64 a[70:71], v116 offset:16384
    ds_read_b64 a[72:73], v117 offset:16384
    ds_read_b64 a[74:75], v118 offset:16384
    ds_read_b64 a[76:77], v119 offset:16384
    ds_read_b64 a[78:79], v120 offset:16384
    v_add_u32 v113, 126976, v112
    v_xor_b32 v114, 32, v113
    v_xor_b32 v115, 64, v113
    v_xor_b32 v116, 96, v113
    v_xor_b32 v117, 128, v113
    v_xor_b32 v118, 160, v113
    v_xor_b32 v119, 192, v113
    v_xor_b32 v120, 224, v113
    s_branch L_barQ
L_l_noattn:
    s_cmp_eq_u32 s64, 5
    s_cbranch_scc1 L_nopre2
    s_mov_b32 s72, 2
L_wo2:
    s_lshl_b32 s74, s72, 2
    s_lshr_b64 s[76:77], s[58:59], s74
    s_and_b32 s76, s76, 15
    s_lshl_b32 s76, s76, 14
    s_add_u32 s76, s76, s86
    s_add_u32 s74, s72, s83
    s_and_b32 s74, s74, 15
    s_lshl_b32 s74, s74, 16
    s_mov_b32 m0, s76
    s_add_u32 s74, s74, s87
    buffer_load_dwordx4 v15, s[36:39], s74 offen offset:0 lds
    buffer_load_dwordx4 v16, s[36:39], s74 offen offset:1024 lds
    buffer_load_dwordx4 v17, s[36:39], s74 offen offset:2048 lds
    buffer_load_dwordx4 v18, s[36:39], s74 offen offset:3072 lds
    s_add_u32 m0, s76, 4096
    s_add_u32 s74, s74, 32768
    buffer_load_dwordx4 v15, s[36:39], s74 offen offset:0 lds
    buffer_load_dwordx4 v16, s[36:39], s74 offen offset:1024 lds
    buffer_load_dwordx4 v17, s[36:39], s74 offen offset:2048 lds
    buffer_load_dwordx4 v18, s[36:39], s74 offen offset:3072 lds
    s_add_u32 s72, s72, 1
    s_cmp_lt_u32 s72, 3
    s_cbranch_scc1 L_wo2
L_nopre2:
    s_barrier
    v_mov_b32 v126, 81920
    ds_read_b32 v126, v126
    s_waitcnt lgkmcnt(0)
    s_barrier
    s_cmp_eq_u32 s64, 5
    s_cbranch_scc1 L_ld_wait
    s_mov_b32 s72, 3
L_wo3:
    s_lshl_b32 s74, s72, 2
    s_lshr_b64 s[76:77], s[58:59], s74
    s_and_b32 s76, s76, 15
    s_lshl_b32 s76, s76, 14
    s_add_u32 s76, s76, s86
    s_add_u32 s74, s72, s83
    s_and_b32 s74, s74, 15
    s_lshl_b32 s74, s74, 16
    s_mov_b32 m0, s76
    s_add_u32 s74, s74, s87
    buffer_load_dwordx4 v15, s[36:39], s74 offen offset:0 lds
    buffer_load_dwordx4 v16, s[36:39], s74 offen offset:1024 lds
    buffer_load_dwordx4 v17, s[36:39], s74 offen offset:2048 lds
    buffer_load_dwordx4 v18, s[36:39], s74 offen offset:3072 lds
    s_add_u32 m0, s76, 4096
    s_add_u32 s74, s74, 32768
    buffer_load_dwordx4 v15, s[36:39], s74 offen offset:0 lds
    buffer_load_dwordx4 v16, s[36:39], s74 offen offset:1024 lds
    buffer_load_dwordx4 v17, s[36:39], s74 offen offset:2048 lds
    buffer_load_dwordx4 v18, s[36:39], s74 offen offset:3072 lds
    s_add_u32 s72, s72, 1
    s_cmp_lt_u32 s72, 8
    s_cbranch_scc1 L_wo3
    s_waitcnt vmcnt(16)
    s_branch L_barA
L_ld_wait:
    s_waitcnt vmcnt(0)
    s_branch L_barA
L_l_k:
    s_lshl_b32 s75, s85, 10
    s_add_u32 m0, s75, 106496
    s_movk_i32 s74, 0
    buffer_load_dwordx4 v6, s[28:31], s74 offen nt lds
    s_add_u32 m0, s75, 110592
    s_movk_i32 s74, 4096
    buffer_load_dwordx4 v6, s[28:31], s74 offen nt lds
    s_add_u32 m0, s75, 114688
    s_movk_i32 s74, 8192
    buffer_load_dwordx4 v6, s[28:31], s74 offen nt lds
    s_add_u32 m0, s75, 118784
    s_movk_i32 s74, 12288
    buffer_load_dwordx4 v6, s[28:31], s74 offen nt lds
    s_add_u32 m0, s75, 122880
    s_movk_i32 s74, 16384
    buffer_load_dwordx4 v6, s[28:31], s74 offen nt lds
    s_add_u32 m0, s75, 126976
    s_movk_i32 s74, 0
    buffer_load_dwordx4 v7, s[32:35], s74 offen nt lds
    s_add_u32 m0, s75, 131072
    s_movk_i32 s74, 4096
    buffer_load_dwordx4 v7, s[32:35], s74 offen nt lds
    s_add_u32 m0, s75, 135168
    s_movk_i32 s74, 8192
    buffer_load_dwordx4 v7, s[32:35], s74 offen nt lds
    s_add_u32 m0, s75, 139264
    s_movk_i32 s74, 12288
    buffer_load_dwordx4 v7, s[32:35], s74 offen nt lds
    s_add_u32 m0, s75, 143360
    s_movk_i32 s74, 16384
    buffer_load_dwordx4 v7, s[32:35], s74 offen nt lds
    s_add_u32 m0, s73, s86
    s_lshl_b32 s89, s88, 7
    s_lshl_b32 s90, s88, 19
    s_add_u32 s72, s72, 1
    s_cmp_lt_u32 s72, 13
    s_waitcnt vmcnt(24)
    s_branch L_l_next
L_compute:
    v_lshrrev_b32 v20, 1, v2
    v_xor_b32 v20, v20, v3
    v_lshlrev_b32 v20, 4, v20
    v_lshl_add_u32 v6, v2, 7, v20
    v_xor_b32 v7, 64, v6
    v_lshrrev_b32 v20, 1, v3
    v_xor_b32 v20, v20, v2
    v_lshlrev_b32 v20, 4, v20
    v_lshl_add_u32 v20, v2, 8, v20
    v_and_b32 v21, 1, v3
    v_lshl_add_u32 v20, v21, 3, v20
    v_add_u32 v113, 106496, v20
    v_xor_b32 v114, 32, v113
    v_xor_b32 v115, 64, v113
    v_xor_b32 v116, 96, v113
    v_xor_b32 v117, 128, v113
    v_xor_b32 v118, 160, v113
    v_xor_b32 v119, 192, v113
    v_xor_b32 v120, 224, v113
    s_lshl_b32 s74, s64, 12
    s_add_u32 s74, s74, 86016
    v_add_u32 v121, s74, v4
    v_mov_b32 v122, 0x3f803f80
    v_mov_b32 v123, 0x3f803f80
    v_mov_b32 v124, 0x3f803f80
    v_mov_b32 v125, 0x3f803f80
    v_bfe_u32 v20, v1, 2, 2
    v_and_b32 v21, 1, v3
    v_lshl_add_u32 v21, v21, 2, v20
    v_lshlrev_b32 v21, 1, v21
    v_bfe_u32 v22, v1, 1, 1
    v_xor_b32 v21, v21, v22
    v_lshl_add_u32 v20, v3, 2, v20
    v_lshlrev_b32 v20, 8, v20
    v_lshl_add_u32 v20, v21, 4, v20
    v_and_b32 v21, 1, v1
    v_lshl_add_u32 v112, v21, 3, v20
    s_lshl_b32 s74, s64, 6
    v_lshl_add_u32 v20, v3, 10, v112
    v_xor_b32 v20, s74, v20
    v_add_u32 v8, 10240, v20
    v_xor_b32 v9, 32, v8
    v_mov_b32 v32, 0
    v_mov_b32 v33, 0
    v_mov_b32 v34, 0
    v_mov_b32 v35, 0
    v_mov_b32 v36, 0
    v_mov_b32 v37, 0
    v_mov_b32 v38, 0
    v_mov_b32 v39, 0
    v_mov_b32 v40, 0
    v_mov_b32 v41, 0
    v_mov_b32 v42, 0
    v_mov_b32 v43, 0
    v_mov_b32 v44, 0
    v_mov_b32 v45, 0
    v_mov_b32 v46, 0
    v_mov_b32 v47, 0
    v_mov_b32 v48, 0
    v_mov_b32 v49, 0
    v_mov_b32 v50, 0
    v_mov_b32 v51, 0
    v_mov_b32 v52, 0
    v_mov_b32 v53, 0
    v_mov_b32 v54, 0
    v_mov_b32 v55, 0
    v_mov_b32 v56, 0
    v_mov_b32 v57, 0
    v_mov_b32 v58, 0
    v_mov_b32 v59, 0
    v_mov_b32 v60, 0
    v_mov_b32 v61, 0
    v_mov_b32 v62, 0
    v_mov_b32 v63, 0
    v_mov_b32 v64, 0
    v_mov_b32 v65, 0
    v_mov_b32 v66, 0
    v_mov_b32 v67, 0
    v_mov_b32 v68, 0
    v_mov_b32 v69, 0
    v_mov_b32 v70, 0
    v_mov_b32 v71, 0
    v_mov_b32 v72, 0
    v_mov_b32 v73, 0
    v_mov_b32 v74, 0
    v_mov_b32 v75, 0
    v_mov_b32 v76, 0
    v_mov_b32 v77, 0
    v_mov_b32 v78, 0
    v_mov_b32 v79, 0
    v_mov_b32 v80, 0
    v_mov_b32 v81, 0
    v_mov_b32 v82, 0
    v_mov_b32 v83, 0
    v_mov_b32 v84, 0
    v_mov_b32 v85, 0
    v_mov_b32 v86, 0
    v_mov_b32 v87, 0
    v_mov_b32 v88, 0
    v_mov_b32 v89, 0
    v_mov_b32 v90, 0
    v_mov_b32 v91, 0
    v_mov_b32 v92, 0
    v_mov_b32 v93, 0
    v_mov_b32 v94, 0
    v_mov_b32 v95, 0
    v_mov_b32 v96, 0
    v_mov_b32 v97, 0
    v_mov_b32 v98, 0
    v_mov_b32 v99, 0
    v_mov_b32 v100, 0
    v_mov_b32 v101, 0
    v_mov_b32 v102, 0
    v_mov_b32 v103, 0
    v_mov_b32 v104, 0
    v_mov_b32 v105, 0
    v_mov_b32 v106, 0
    v_mov_b32 v107, 0
    v_mov_b32 v108, 0
    v_mov_b32 v109, 0
    v_mov_b32 v110, 0
    v_mov_b32 v111, 0
    s_mov_b32 s73, 26624
    v_add_u32 v10, s73, v6
    v_add_u32 v12, s73, v8
    v_add_u32 v11, s73, v7
    v_add_u32 v13, s73, v9
    s_waitcnt lgkmcnt(0)
    s_lshl_b32 s74, s69, 21
    s_lshl_b32 s75, s70, 8
    s_add_u32 s74, s74, s75
    s_sub_u32 s75, 0x800000, s74
    s_add_u32 s36, s12, s74
    s_addc_u32 s37, s13, 0
    s_mov_b32 s38, s75
    s_mov_b32 s39, 0x20000
    s_lshl_b32 s76, s67, 2
    s_add_u32 s76, s76, s69
    s_mul_i32 s74, s76, 163840
    s_add_u32 s40, s18, s74
    s_addc_u32 s41, s19, 0
    s_mov_b32 s42, 163840
    s_mov_b32 s43, 0x20000
    s_lshl_b32 s74, s76, 8
    s_add_u32 s74, s74, 5242880
    s_add_u32 s44, s18, s74
    s_addc_u32 s45, s19, 0
    s_mov_b32 s46, 256
    s_mov_b32 s47, 0x20000
    s_add_u32 s48, s18, 6291456
    s_addc_u32 s49, s19, 0
    s_mov_b32 s50, 7865344
    s_mov_b32 s51, 0x20000
    s_mov_b32 s52, s14
    s_mov_b32 s53, s15
    s_mov_b32 s54, 1310720
    s_mov_b32 s55, 0x20000
    s_movk_i32 s56, 0xff
    s_mul_i32 s94, s2, 30720
    s_lshl_b32 s83, s67, 1
    s_lshr_b32 s84, s64, 2
    s_and_b32 s85, s64, 3
    s_mov_b32 s82, 0x3e0293ee
    s_cmp_lg_u32 s64, 0
    s_cbranch_scc1 L_noep
    s_lshl_b32 s74, s67, 7
    s_add_u32 s74, s74, 7864320
    v_mov_b32 v14, 0
    buffer_load_dword v15, v14, s[48:51], s74 offen sc1
L_noep:
    s_mov_b32 s72, 0
L_cloop:
    s_barrier
    ds_read_b128 v[16:19], v10 offset:0
    ds_read_b128 v[20:23], v10 offset:2048
    v_mfma_f32_16x16x32_bf16 v[104:107], v[36:39], v[32:35], v[104:107]
    ds_read_b128 v[24:27], v10 offset:4096
    ds_read_b128 v[28:31], v10 offset:6144
    v_mfma_f32_16x16x32_bf16 v[108:111], v[40:43], v[32:35], v[108:111]
    ds_read_b64_tr_b16 v[36:37], v12 offset:0
    ds_read_b64_tr_b16 v[38:39], v12 offset:1024
    v_mfma_f32_16x16x32_bf16 v[72:75], v[64:67], v[44:47], v[72:75]
    ds_read_b64_tr_b16 v[40:41], v13 offset:0
    ds_read_b64_tr_b16 v[42:43], v13 offset:1024
    v_mfma_f32_16x16x32_bf16 v[76:79], v[68:71], v[44:47], v[76:79]
    ds_read_b128 v[32:35], v10 offset:8192
    ds_read_b128 v[44:47], v11 offset:0
    v_mfma_f32_16x16x32_bf16 v[80:83], v[64:67], v[48:51], v[80:83]
    v_mfma_f32_16x16x32_bf16 v[84:87], v[68:71], v[48:51], v[84:87]
    ds_read_b128 v[48:51], v11 offset:2048
    v_mfma_f32_16x16x32_bf16 v[88:91], v[64:67], v[52:55], v[88:91]
    v_mfma_f32_16x16x32_bf16 v[92:95], v[68:71], v[52:55], v[92:95]
    ds_read_b128 v[52:55], v11 offset:4096
    v_mfma_f32_16x16x32_bf16 v[96:99], v[64:67], v[56:59], v[96:99]
    v_mfma_f32_16x16x32_bf16 v[100:103], v[68:71], v[56:59], v[100:103]
    ds_read_b128 v[56:59], v11 offset:6144
    v_mfma_f32_16x16x32_bf16 v[104:107], v[64:67], v[60:63], v[104:107]
    v_mfma_f32_16x16x32_bf16 v[108:111], v[68:71], v[60:63], v[108:111]
    ds_read_b64_tr_b16 v[64:65], v12 offset:8192
    ds_read_b64_tr_b16 v[66:67], v12 offset:9216
    s_waitcnt lgkmcnt(9)
    v_mfma_f32_16x16x32_bf16 v[72:75], v[36:39], v[16:19], v[72:75]
    ds_read_b64_tr_b16 v[68:69], v13 offset:8192
    ds_read_b64_tr_b16 v[70:71], v13 offset:9216
    s_waitcnt lgkmcnt(9)
    v_mfma_f32_16x16x32_bf16 v[76:79], v[40:43], v[16:19], v[76:79]
    ds_read_b128 v[60:63], v11 offset:8192
    v_mfma_f32_16x16x32_bf16 v[80:83], v[36:39], v[20:23], v[80:83]
    s_add_u32 s73, s73, 26624
    s_cmp_eq_u32 s73, 106496
    v_mfma_f32_16x16x32_bf16 v[84:87], v[40:43], v[20:23], v[84:87]
    s_cselect_b32 s73, 0, s73
    s_add_u32 s72, s72, 1
    v_mfma_f32_16x16x32_bf16 v[88:91], v[36:39], v[24:27], v[88:91]
    v_add_u32 v10, s73, v6
    v_add_u32 v12, s73, v8
    v_mfma_f32_16x16x32_bf16 v[92:95], v[40:43], v[24:27], v[92:95]
    v_add_u32 v11, s73, v7
    v_add_u32 v13, s73, v9
    v_mfma_f32_16x16x32_bf16 v[96:99], v[36:39], v[28:31], v[96:99]
    s_cmp_lt_u32 s72, 15
    v_mfma_f32_16x16x32_bf16 v[100:103], v[40:43], v[28:31], v[100:103]
    s_waitcnt lgkmcnt(0)
    s_cbranch_scc1 L_cloop
    s_barrier
    ds_read_b128 v[16:19], v10 offset:0
    ds_read_b128 v[20:23], v10 offset:2048
    v_mfma_f32_16x16x32_bf16 v[104:107], v[36:39], v[32:35], v[104:107]
    ds_read_b128 v[24:27], v10 offset:4096
    ds_read_b128 v[28:31], v10 offset:6144
    v_mfma_f32_16x16x32_bf16 v[108:111], v[40:43], v[32:35], v[108:111]
    ds_read_b64_tr_b16 v[36:37], v12 offset:0
    ds_read_b64_tr_b16 v[38:39], v12 offset:1024
    v_mfma_f32_16x16x32_bf16 v[72:75], v[64:67], v[44:47], v[72:75]
    ds_read_b64_tr_b16 v[40:41], v13 offset:0
    ds_read_b64_tr_b16 v[42:43], v13 offset:1024
    v_mfma_f32_16x16x32_bf16 v[76:79], v[68:71], v[44:47], v[76:79]
    ds_read_b128 v[32:35], v10 offset:8192
    ds_read_b128 v[44:47], v11 offset:0
    v_mfma_f32_16x16x32_bf16 v[80:83], v[64:67], v[48:51], v[80:83]
    v_mfma_f32_16x16x32_bf16 v[84:87], v[68:71], v[48:51], v[84:87]
    ds_read_b128 v[48:51], v11 offset:2048
    v_mfma_f32_16x16x32_bf16 v[88:91], v[64:67], v[52:55], v[88:91]
    v_mfma_f32_16x16x32_bf16 v[92:95], v[68:71], v[52:55], v[92:95]
    ds_read_b128 v[52:55], v11 offset:4096
    v_mfma_f32_16x16x32_bf16 v[96:99], v[64:67], v[56:59], v[96:99]
    v_mfma_f32_16x16x32_bf16 v[100:103], v[68:71], v[56:59], v[100:103]
    ds_read_b128 v[56:59], v11 offset:6144
    v_mfma_f32_16x16x32_bf16 v[104:107], v[64:67], v[60:63], v[104:107]
    v_mfma_f32_16x16x32_bf16 v[108:111], v[68:71], v[60:63], v[108:111]
    ds_read_b64_tr_b16 v[64:65], v12 offset:8192
    ds_read_b64_tr_b16 v[66:67], v12 offset:9216
    s_waitcnt lgkmcnt(9)
    v_mfma_f32_16x16x32_bf16 v[72:75], v[36:39], v[16:19], v[72:75]
    ds_read_b64_tr_b16 v[68:69], v13 offset:8192
    ds_read_b64_tr_b16 v[70:71], v13 offset:9216
    s_waitcnt lgkmcnt(9)
    v_mfma_f32_16x16x32_bf16 v[76:79], v[40:43], v[16:19], v[76:79]
    ds_read_b128 v[60:63], v11 offset:8192
    s_lshl_b32 s74, s64, 10
    s_add_u32 s74, s74, 86016
    v_mfma_f32_16x16x32_bf16 v[80:83], v[36:39], v[20:23], v[80:83]
    v_add_u32 v6, s74, v4
    ds_read_b64 a[0:1], v113 offset:0
    ds_read_b64 a[2:3], v114 offset:0
    ds_read_b64 a[4:5], v115 offset:0
    v_mfma_f32_16x16x32_bf16 v[84:87], v[40:43], v[20:23], v[84:87]
    ds_read_b64 a[6:7], v116 offset:0
    ds_read_b64 a[8:9], v117 offset:0
    ds_read_b64 a[10:11], v118 offset:0
    v_mfma_f32_16x16x32_bf16 v[88:91], v[36:39], v[24:27], v[88:91]
    ds_read_b64 a[12:13], v119 offset:0
    ds_read_b64 a[14:15], v120 offset:0
    ds_read_b64 a[16:17], v113 offset:4096
    v_mfma_f32_16x16x32_bf16 v[92:95], v[40:43], v[24:27], v[92:95]
    ds_read_b64 a[18:19], v114 offset:4096
    ds_read_b64 a[20:21], v115 offset:4096
    ds_read_b64 a[22:23], v116 offset:4096
    v_mfma_f32_16x16x32_bf16 v[96:99], v[36:39], v[28:31], v[96:99]
    ds_read_b64 a[24:25], v117 offset:4096
    ds_read_b64 a[26:27], v118 offset:4096
    ds_read_b64 a[28:29], v119 offset:4096
    v_mfma_f32_16x16x32_bf16 v[100:103], v[40:43], v[28:31], v[100:103]
    ds_read_b64 a[30:31], v120 offset:4096
    ds_read_b64 a[32:33], v113 offset:8192
    ds_read_b64 a[34:35], v114 offset:8192
    s_waitcnt lgkmcnt(15)
    v_mfma_f32_16x16x32_bf16 v[104:107], v[36:39], v[32:35], v[104:107]
    ds_read_b64 a[36:37], v115 offset:8192
    ds_read_b64 a[38:39], v116 offset:8192
    ds_read_b64 a[40:41], v117 offset:8192
    v_mfma_f32_16x16x32_bf16 v[108:111], v[40:43], v[32:35], v[108:111]
    ds_read_b64 a[42:43], v118 offset:8192
    ds_read_b64 a[44:45], v119 offset:8192
    ds_read_b64 a[46:47], v120 offset:8192
    s_waitcnt lgkmcnt(15)
    v_mfma_f32_16x16x32_bf16 v[72:75], v[64:67], v[44:47], v[72:75]
    ds_read_b64 a[48:49], v113 offset:12288
    ds_read_b64 a[50:51], v114 offset:12288
    ds_read_b64 a[52:53], v115 offset:12288
    v_mfma_f32_16x16x32_bf16 v[76:79], v[68:71], v[44:47], v[76:79]
    ds_read_b64 a[54:55], v116 offset:12288
    ds_read_b64 a[56:57], v117 offset:12288
    ds_read_b64 a[58:59], v118 offset:12288
    v_mfma_f32_16x16x32_bf16 v[80:83], v[64:67], v[48:51], v[80:83]
    ds_read_b64 a[60:61], v119 offset:12288
    ds_read_b64 a[62:63], v120 offset:12288
    ds_read_b64 a[64:65], v113 offset:16384
    v_mfma_f32_16x16x32_bf16 v[84:87], v[68:71], v[48:51], v[84:87]
    ds_read_b64 a[66:67], v114 offset:16384
    ds_read_b64 a[68:69], v115 offset:16384
    ds_read_b64 a[70:71], v116 offset:16384
    v_mfma_f32_16x16x32_bf16 v[88:91], v[64:67], v[52:55], v[88:91]
    ds_read_b64 a[72:73], v117 offset:16384
    ds_read_b64 a[74:75], v118 offset:16384
    ds_read_b64 a[76:77], v119 offset:16384
    v_mfma_f32_16x16x32_bf16 v[92:95], v[68:71], v[52:55], v[92:95]
    ds_read_b64 a[78:79], v120 offset:16384
    v_mfma_f32_16x16x32_bf16 v[96:99], v[64:67], v[56:59], v[96:99]
    v_cvt_pk_bf16_f32 v16, v72, v73
    v_cvt_pk_bf16_f32 v17, v74, v75
    v_mfma_f32_16x16x32_bf16 v[100:103], v[68:71], v[56:59], v[100:103]
    v_cvt_pk_bf16_f32 v18, v76, v77
    v_cvt_pk_bf16_f32 v19, v78, v79
    v_mfma_f32_16x16x32_bf16 v[104:107], v[64:67], v[60:63], v[104:107]
    ds_write_b128 v6, v[16:19] offset:0
    v_cvt_pk_bf16_f32 v20, v80, v81
    v_cvt_pk_bf16_f32 v21, v82, v83
    v_mfma_f32_16x16x32_bf16 v[108:111], v[68:71], v[60:63], v[108:111]
    v_cvt_pk_bf16_f32 v22, v84, v85
    v_cvt_pk_bf16_f32 v23, v86, v87
    ds_write_b128 v6, v[20:23] offset:4096
    v_cvt_pk_bf16_f32 v24, v88, v89
    v_cvt_pk_bf16_f32 v25, v90, v91
    v_cvt_pk_bf16_f32 v26, v92, v93
    v_cvt_pk_bf16_f32 v27, v94, v95
    ds_write_b128 v6, v[24:27] offset:8192
    v_cvt_pk_bf16_f32 v28, v96, v97
    v_cvt_pk_bf16_f32 v29, v98, v99
    v_cvt_pk_bf16_f32 v30, v100, v101
    v_cvt_pk_bf16_f32 v31, v102, v103
    ds_write_b128 v6, v[28:31] offset:12288
    v_cvt_pk_bf16_f32 v32, v104, v105
    v_cvt_pk_bf16_f32 v33, v106, v107
    v_cvt_pk_bf16_f32 v34, v108, v109
    v_cvt_pk_bf16_f32 v35, v110, v111
    ds_write_b128 v6, v[32:35] offset:16384
    v_add_u32 v113, 126976, v112
    v_xor_b32 v114, 32, v113
    v_xor_b32 v115, 64, v113
    v_xor_b32 v116, 96, v113
    v_xor_b32 v117, 128, v113
    v_xor_b32 v118, 160, v113
    v_xor_b32 v119, 192, v113
    v_xor_b32 v120, 224, v113
    s_waitcnt vmcnt(0)
    s_cmp_lg_u32 s64, 0
    s_cbranch_scc1 L_barQ
    v_mov_b32 v14, 81920
    v_add_u32 v15, 1, v15
    ds_write_b32 v14, v15
L_barQ:
    s_waitcnt lgkmcnt(0)
    s_barrier
    v_mov_b32 v126, 81920
    ds_read_b32 v126, v126
    ds_read_b128 v[16:19], v121 offset:0
    ds_read_b128 v[20:23], v121 offset:1024
    ds_read_b128 v[24:27], v121 offset:2048
    ds_read_b128 v[28:31], v121 offset:3072
    s_waitcnt lgkmcnt(0)
    s_barrier
    v_mfma_f32_16x16x32_bf16 v[32:35], a[0:3], v[16:19], 0
    ds_read_b64_tr_b16 a[80:81], v113 offset:0
    v_mfma_f32_16x16x32_bf16 v[36:39], a[16:19], v[16:19], 0
    ds_read_b64_tr_b16 a[82:83], v113 offset:4096
    v_mfma_f32_16x16x32_bf16 v[40:43], a[32:35], v[16:19], 0
    ds_read_b64_tr_b16 a[84:85], v113 offset:8192
    v_mfma_f32_16x16x32_bf16 v[44:47], a[48:51], v[16:19], 0
    ds_read_b64_tr_b16 a[86:87], v113 offset:12288
    v_mfma_f32_16x16x32_bf16 v[48:51], a[64:67], v[16:19], 0
    ds_read_b64_tr_b16 a[88:89], v113 offset:16384
    v_mfma_f32_16x16x32_bf16 v[32:35], a[4:7], v[20:23], v[32:35]
    ds_read_b64_tr_b16 a[90:91], v114 offset:0
    v_mfma_f32_16x16x32_bf16 v[36:39], a[20:23], v[20:23], v[36:39]
    ds_read_b64_tr_b16 a[92:93], v114 offset:4096
    v_mfma_f32_16x16x32_bf16 v[40:43], a[36:39], v[20:23], v[40:43]
    ds_read_b64_tr_b16 a[94:95], v114 offset:8192
    v_mfma_f32_16x16x32_bf16 v[44:47], a[52:55], v[20:23], v[44:47]
    ds_read_b64_tr_b16 a[96:97], v114 offset:12288
    v_mfma_f32_16x16x32_bf16 v[48:51], a[68:71], v[20:23], v[48:51]
    ds_read_b64_tr_b16 a[98:99], v114 offset:16384
    v_mfma_f32_16x16x32_bf16 v[32:35], a[8:11], v[24:27], v[32:35]
    ds_read_b64_tr_b16 a[100:101], v115 offset:0
    v_mfma_f32_16x16x32_bf16 v[36:39], a[24:27], v[24:27], v[36:39]
    ds_read_b64_tr_b16 a[102:103], v115 offset:4096
    v_mfma_f32_16x16x32_bf16 v[40:43], a[40:43], v[24:27], v[40:43]
    ds_read_b64_tr_b16 a[104:105], v115 offset:8192
    v_mfma_f32_16x16x32_bf16 v[44:47], a[56:59], v[24:27], v[44:47]
    ds_read_b64_tr_b16 a[106:107], v115 offset:12288
    v_mfma_f32_16x16x32_bf16 v[48:51], a[72:75], v[24:27], v[48:51]
    ds_read_b64_tr_b16 a[108:109], v115 offset:16384
    v_mfma_f32_16x16x32_bf16 v[32:35], a[12:15], v[28:31], v[32:35]
    ds_read_b64_tr_b16 a[110:111], v116 offset:0
    v_mfma_f32_16x16x32_bf16 v[36:39], a[28:31], v[28:31], v[36:39]
    ds_read_b64_tr_b16 a[112:113], v116 offset:4096
    v_mfma_f32_16x16x32_bf16 v[40:43], a[44:47], v[28:31], v[40:43]
    ds_read_b64_tr_b16 a[114:115], v116 offset:8192
    v_mfma_f32_16x16x32_bf16 v[44:47], a[60:63], v[28:31], v[44:47]
    ds_read_b64_tr_b16 a[116:117], v116 offset:12288
    v_mfma_f32_16x16x32_bf16 v[48:51], a[76:79], v[28:31], v[48:51]
    ds_read_b64_tr_b16 a[118:119], v116 offset:16384
    ds_read_b64_tr_b16 a[0:1], v117 offset:0
    ds_read_b64_tr_b16 a[2:3], v117 offset:4096
    ds_read_b64_tr_b16 a[4:5], v117 offset:8192
    ds_read_b64_tr_b16 a[6:7], v117 offset:12288
    ds_read_b64_tr_b16 a[8:9], v117 offset:16384
    v_max3_f32 v14, v32, v33, v34
    v_max3_f32 v15, v35, v36, v37
    v_max3_f32 v14, v14, v38, v39
    v_max3_f32 v15, v15, v40, v41
    v_max3_f32 v14, v14, v42, v43
    v_max3_f32 v15, v15, v44, v45
    v_max3_f32 v14, v14, v46, v47
    v_max3_f32 v15, v15, v48, v49
    v_max3_f32 v14, v14, v50, v51
    v_max_f32 v14, v14, v15
    v_mov_b32 v15, v14
    ds_read_b64_tr_b16 a[10:11], v118 offset:0
    ds_read_b64_tr_b16 a[12:13], v118 offset:4096
    v_permlane32_swap_b32 v14, v15
    v_max_f32 v14, v14, v15
    v_mov_b32 v15, v14
    ds_read_b64_tr_b16 a[14:15], v118 offset:8192
    ds_read_b64_tr_b16 a[16:17], v118 offset:12288
    v_permlane16_swap_b32 v14, v15
    v_max_f32 v14, v14, v15
    v_mul_f32 v14, s82, v14
    v_fma_f32 v32, v32, s82, -v14
    ds_read_b64_tr_b16 a[18:19], v118 offset:16384
    v_fma_f32 v33, v33, s82, -v14
    ds_read_b64_tr_b16 a[20:21], v119 offset:0
    v_fma_f32 v34, v34, s82, -v14
    ds_read_b64_tr_b16 a[22:23], v119 offset:4096
    v_fma_f32 v35, v35, s82, -v14
    ds_read_b64_tr_b16 a[24:25], v119 offset:8192
    v_fma_f32 v36, v36, s82, -v14
    ds_read_b64_tr_b16 a[26:27], v119 offset:12288
    v_fma_f32 v37, v37, s82, -v14
    ds_read_b64_tr_b16 a[28:29], v119 offset:16384
    v_fma_f32 v38, v38, s82, -v14
    ds_read_b64_tr_b16 a[30:31], v120 offset:0
    v_fma_f32 v39, v39, s82, -v14
    ds_read_b64_tr_b16 a[32:33], v120 offset:4096
    v_fma_f32 v40, v40, s82, -v14
    ds_read_b64_tr_b16 a[34:35], v120 offset:8192
    v_fma_f32 v41, v41, s82, -v14
    ds_read_b64_tr_b16 a[36:37], v120 offset:12288
    v_fma_f32 v42, v42, s82, -v14
    ds_read_b64_tr_b16 a[38:39], v120 offset:16384
    v_fma_f32 v43, v43, s82, -v14
    v_fma_f32 v44, v44, s82, -v14
    v_fma_f32 v45, v45, s82, -v14
    v_fma_f32 v46, v46, s82, -v14
    v_fma_f32 v47, v47, s82, -v14
    v_fma_f32 v48, v48, s82, -v14
    v_fma_f32 v49, v49, s82, -v14
    v_fma_f32 v50, v50, s82, -v14
    v_fma_f32 v51, v51, s82, -v14
    v_exp_f32 v48, v48
    v_exp_f32 v49, v49
    v_exp_f32 v50, v50
    v_exp_f32 v51, v51
    v_exp_f32 v32, v32
    v_exp_f32 v33, v33
    v_exp_f32 v34, v34
    v_exp_f32 v35, v35
    v_exp_f32 v36, v36
    v_exp_f32 v37, v37
    v_exp_f32 v38, v38
    v_exp_f32 v39, v39
    v_exp_f32 v40, v40
    v_exp_f32 v41, v41
    v_exp_f32 v42, v42
    v_exp_f32 v43, v43
    v_exp_f32 v44, v44
    v_exp_f32 v45, v45
    v_exp_f32 v46, v46
    v_exp_f32 v47, v47
    v_cvt_pk_bf16_f32 v60, v48, v49
    v_cvt_pk_bf16_f32 v61, v50, v51
    v_cvt_pk_bf16_f32 v52, v32, v33
    v_cvt_pk_bf16_f32 v53, v34, v35
    v_cvt_pk_bf16_f32 v54, v36, v37
    v_cvt_pk_bf16_f32 v55, v38, v39
    v_cvt_pk_bf16_f32 v56, v40, v41
    v_cvt_pk_bf16_f32 v57, v42, v43
    v_cvt_pk_bf16_f32 v58, v44, v45
    v_cvt_pk_bf16_f32 v59, v46, v47
    s_waitcnt lgkmcnt(0)
    v_mfma_f32_16x16x16_bf16 v[108:111], v[122:123], v[60:61], 0
    v_mfma_f32_16x16x16_bf16 v[66:69], a[88:89], v[60:61], 0
    v_mfma_f32_16x16x16_bf16 v[70:73], a[98:99], v[60:61], 0
    v_mfma_f32_16x16x16_bf16 v[74:77], a[108:109], v[60:61], 0
    v_mfma_f32_16x16x16_bf16 v[78:81], a[118:119], v[60:61], 0
    v_mfma_f32_16x16x16_bf16 v[82:85], a[8:9], v[60:61], 0
    v_mfma_f32_16x16x16_bf16 v[86:89], a[18:19], v[60:61], 0
    v_mfma_f32_16x16x16_bf16 v[90:93], a[28:29], v[60:61], 0
    v_mfma_f32_16x16x16_bf16 v[94:97], a[38:39], v[60:61], 0
    v_mfma_f32_16x16x32_bf16 v[108:111], v[122:125], v[52:55], v[108:111]
    v_mfma_f32_16x16x32_bf16 v[108:111], v[122:125], v[56:59], v[108:111]
    s_lshl_b32 s74, s64, 15
    s_lshl_b32 s75, s70, 12
    s_add_u32 s74, s74, s75
    v_mfma_f32_16x16x32_bf16 v[66:69], a[80:83], v[52:55], v[66:69]
    v_mfma_f32_16x16x32_bf16 v[66:69], a[84:87], v[56:59], v[66:69]
    v_mfma_f32_16x16x32_bf16 v[70:73], a[90:93], v[52:55], v[70:73]
    v_mfma_f32_16x16x32_bf16 v[70:73], a[94:97], v[56:59], v[70:73]
    v_mfma_f32_16x16x32_bf16 v[74:77], a[100:103], v[52:55], v[74:77]
    v_mfma_f32_16x16x32_bf16 v[74:77], a[104:107], v[56:59], v[74:77]
    v_mfma_f32_16x16x32_bf16 v[78:81], a[110:113], v[52:55], v[78:81]
    v_mfma_f32_16x16x32_bf16 v[78:81], a[114:117], v[56:59], v[78:81]
    v_rcp_f32 v14, v108
    v_mfma_f32_16x16x32_bf16 v[82:85], a[0:3], v[52:55], v[82:85]
    v_mfma_f32_16x16x32_bf16 v[82:85], a[4:7], v[56:59], v[82:85]
    v_mul_f32 v66, v14, v66
    v_mul_f32 v67, v14, v67
    v_mul_f32 v68, v14, v68
    v_mul_f32 v69, v14, v69
    v_mfma_f32_16x16x32_bf16 v[86:89], a[10:13], v[52:55], v[86:89]
    v_mfma_f32_16x16x32_bf16 v[86:89], a[14:17], v[56:59], v[86:89]
    v_mul_f32 v70, v14, v70
    v_mul_f32 v71, v14, v71
    v_mul_f32 v72, v14, v72
    v_mul_f32 v73, v14, v73
    v_mfma_f32_16x16x32_bf16 v[90:93], a[20:23], v[52:55], v[90:93]
    v_mfma_f32_16x16x32_bf16 v[90:93], a[24:27], v[56:59], v[90:93]
    v_mul_f32 v74, v14, v74
    v_mul_f32 v75, v14, v75
    v_mul_f32 v76, v14, v76
    v_mul_f32 v77, v14, v77
    v_cvt_pk_bf16_f32 v16, v66, v67
    v_cvt_pk_bf16_f32 v17, v68, v69
    v_cvt_pk_bf16_f32 v18, v70, v71
    v_cvt_pk_bf16_f32 v19, v72, v73
    buffer_store_dwordx4 v[16:19], v4, s[40:43], s74 offen offset:0 sc1
    v_mfma_f32_16x16x32_bf16 v[94:97], a[30:33], v[52:55], v[94:97]
    v_mfma_f32_16x16x32_bf16 v[94:97], a[34:37], v[56:59], v[94:97]
    v_mul_f32 v78, v14, v78
    v_mul_f32 v79, v14, v79
    v_mul_f32 v80, v14, v80
    v_mul_f32 v81, v14, v81
    v_cvt_pk_bf16_f32 v20, v74, v75
    v_cvt_pk_bf16_f32 v21, v76, v77
    v_cvt_pk_bf16_f32 v22, v78, v79
    v_cvt_pk_bf16_f32 v23, v80, v81
    buffer_store_dwordx4 v[20:23], v4, s[40:43], s74 offen offset:1024 sc1
    v_mul_f32 v82, v14, v82
    v_mul_f32 v83, v14, v83
    v_mul_f32 v84, v14, v84
    v_mul_f32 v85, v14, v85
    v_mul_f32 v86, v14, v86
    v_mul_f32 v87, v14, v87
    v_mul_f32 v88, v14, v88
    v_mul_f32 v89, v14, v89
    v_cvt_pk_bf16_f32 v24, v82, v83
    v_cvt_pk_bf16_f32 v25, v84, v85
    v_cvt_pk_bf16_f32 v26, v86, v87
    v_cvt_pk_bf16_f32 v27, v88, v89
    buffer_store_dwordx4 v[24:27], v4, s[40:43], s74 offen offset:2048 sc1
    v_mul_f32 v90, v14, v90
    v_mul_f32 v91, v14, v91
    v_mul_f32 v92, v14, v92
    v_mul_f32 v93, v14, v93
    v_mul_f32 v94, v14, v94
    v_mul_f32 v95, v14, v95
    v_mul_f32 v96, v14, v96
    v_mul_f32 v97, v14, v97
    v_cvt_pk_bf16_f32 v28, v90, v91
    v_cvt_pk_bf16_f32 v29, v92, v93
    v_cvt_pk_bf16_f32 v30, v94, v95
    v_cvt_pk_bf16_f32 v31, v96, v97
    buffer_store_dwordx4 v[28:31], v4, s[40:43], s74 offen offset:3072 sc1
    s_waitcnt vmcnt(4)
    s_cmp_eq_u32 s64, 4
    s_cbranch_scc1 L_barA
    s_lshl_b32 s74, s85, 6
    s_lshl_b32 s75, s84, 13
    v_xor_b32 v98, s74, v112
    v_add_u32 v98, s75, v98
    v_xor_b32 v99, 32, v98
    v_add_u32 v100, 0x10000, v98
    v_add_u32 v102, 0x20000, v98
    v_add_u32 v101, 0x10000, v99
    v_add_u32 v103, 0x20000, v99
    s_lshl_b32 s74, s84, 14
    v_add_u32 v9, s74, v4
    s_lshl_b32 s90, s64, 12
    s_lshl_b32 s75, s85, 2
    s_sub_u32 s75, s75, s83
    s_add_u32 s75, s75, 0
    s_and_b32 s75, s75, 15
    s_lshl_b32 s75, s75, 10
    s_add_u32 s91, s75, s74
    s_lshl_b32 s75, s85, 2
    s_sub_u32 s75, s75, s83
    s_add_u32 s75, s75, 2
    s_and_b32 s75, s75, 15
    s_lshl_b32 s75, s75, 10
    s_add_u32 s92, s75, s74
    s_lshl_b32 s74, s85, 11
    s_add_u32 s74, s74, 147456
    v_add_u32 v10, s74, v4
    v_add_u32 v11, 8192, v10
    v_lshlrev_b32 v8, 11, v2
    v_and_b32 v6, 1, v3
    v_lshl_add_u32 v8, v6, 5, v8
    v_lshrrev_b32 v6, 1, v3
    v_lshl_add_u32 v8, v6, 4, v8
    v_add_u32 v6, 81920, v9
    v_add_u32 v7, 114688, v9
    s_lshl_b32 s74, s85, 9
    s_add_u32 s74, s74, 65536
    v_lshl_add_u32 v104, v1, 2, s74
L_barA:
    v_readfirstlane_b32 s95, v126
    v_and_b32 v13, 0xff, v126
    s_barrier
    s_cmp_ge_u32 s64, 6
    s_cbranch_scc1 L_wo_ld
    ds_read_b64_tr_b16 a[0:1], v102 offset:16384
    ds_read_b64_tr_b16 a[2:3], v102 offset:20480
    ds_read_b64_tr_b16 a[4:5], v103 offset:16384
    ds_read_b64_tr_b16 a[6:7], v103 offset:20480
    ds_read_b64_tr_b16 a[8:9], v98 offset:32768
    ds_read_b64_tr_b16 a[10:11], v98 offset:36864
    ds_read_b64_tr_b16 a[12:13], v99 offset:32768
    ds_read_b64_tr_b16 a[14:15], v99 offset:36864
    ds_read_b64_tr_b16 a[16:17], v98 offset:49152
    ds_read_b64_tr_b16 a[18:19], v98 offset:53248
    ds_read_b64_tr_b16 a[20:21], v99 offset:49152
    ds_read_b64_tr_b16 a[22:23], v99 offset:53248
    ds_read_b64_tr_b16 a[24:25], v100 offset:0
    ds_read_b64_tr_b16 a[26:27], v100 offset:4096
    ds_read_b64_tr_b16 a[28:29], v101 offset:0
    ds_read_b64_tr_b16 a[30:31], v101 offset:4096
    ds_read_b64_tr_b16 a[32:33], v98 offset:0
    ds_read_b64_tr_b16 a[34:35], v98 offset:4096
    ds_read_b64_tr_b16 a[36:37], v99 offset:0
    ds_read_b64_tr_b16 a[38:39], v99 offset:4096
    ds_read_b64_tr_b16 a[40:41], v98 offset:16384
    ds_read_b64_tr_b16 a[42:43], v98 offset:20480
    ds_read_b64_tr_b16 a[44:45], v99 offset:16384
    ds_read_b64_tr_b16 a[46:47], v99 offset:20480
    s_cmp_ge_u32 s64, 4
    s_cbranch_scc1 L_noack
    s_waitcnt vmcnt(0)
L_noack:
    s_waitcnt lgkmcnt(0)
    s_barrier
    s_cmp_lg_u32 s64, 0
    s_cbranch_scc1 L_noflag
    s_lshl_b32 s74, s70, 2
    v_mov_b32 v20, s95
    v_mov_b32 v21, 0
    s_mov_b64 exec, 1
    s_waitcnt vmcnt(0)
    buffer_store_dword v20, v21, s[44:47], s74 offen offset:0 sc1
    s_mov_b64 exec, -1
L_noflag:
    s_barrier
    ds_read_b64_tr_b16 a[48:49], v100 offset:16384
    ds_read_b64_tr_b16 a[50:51], v100 offset:20480
    ds_read_b64_tr_b16 a[52:53], v101 offset:16384
    ds_read_b64_tr_b16 a[54:55], v101 offset:20480
    ds_read_b64_tr_b16 a[56:57], v100 offset:32768
    ds_read_b64_tr_b16 a[58:59], v100 offset:36864
    ds_read_b64_tr_b16 a[60:61], v101 offset:32768
    ds_read_b64_tr_b16 a[62:63], v101 offset:36864
    ds_read_b64_tr_b16 a[64:65], v100 offset:49152
    ds_read_b64_tr_b16 a[66:67], v100 offset:53248
    ds_read_b64_tr_b16 a[68:69], v101 offset:49152
    ds_read_b64_tr_b16 a[70:71], v101 offset:53248
    ds_read_b64_tr_b16 a[72:73], v102 offset:0
    ds_read_b64_tr_b16 a[74:75], v102 offset:4096
    ds_read_b64_tr_b16 a[76:77], v103 offset:0
    ds_read_b64_tr_b16 a[78:79], v103 offset:4096
    s_cmp_lg_u32 s64, 4
    s_cbranch_scc1 L_noflag4
    s_lshl_b32 s74, s70, 2
    v_mov_b32 v20, s95
    v_mov_b32 v21, 0
    s_mov_b64 exec, 1
    s_waitcnt vmcnt(0)
    buffer_store_dword v20, v21, s[44:47], s74 offen offset:128 sc1
    s_mov_b64 exec, -1
L_noflag4:
    s_cmp_lg_u32 s64, 5
    s_cbranch_scc1 L_nopoll
    s_waitcnt lgkmcnt(0)
    s_mov_b32 s75, 0
L_polla:
    s_load_dwordx8 s[20:27], s[44:45], 0 glc
    s_add_u32 s75, s75, 1
    s_cmp_gt_u32 s75, 65536
    s_waitcnt lgkmcnt(0)
    s_cbranch_scc1 L_polleda
    s_mov_b32 s76, s95
    s_mov_b32 s77, s95
    s_xor_b64 s[20:21], s[20:21], s[76:77]
    s_xor_b64 s[22:23], s[22:23], s[76:77]
    s_or_b64 s[20:21], s[20:21], s[22:23]
    s_xor_b64 s[24:25], s[24:25], s[76:77]
    s_or_b64 s[20:21], s[20:21], s[24:25]
    s_xor_b64 s[26:27], s[26:27], s[76:77]
    s_or_b64 s[20:21], s[20:21], s[26:27]
    s_cbranch_scc1 L_polla
L_polleda:
L_nopoll:
    s_waitcnt lgkmcnt(0)
    s_barrier
    s_cmp_lg_u32 s64, 5
    s_cbranch_scc1 L_nopeek
    s_load_dwordx8 s[20:27], s[44:45], 128 glc
L_nopeek:
    s_barrier
    ds_read_b64_tr_b16 a[80:81], v102 offset:16384
    ds_read_b64_tr_b16 a[82:83], v102 offset:20480
    ds_read_b64_tr_b16 a[84:85], v103 offset:16384
    ds_read_b64_tr_b16 a[86:87], v103 offset:20480
    ds_read_b64_tr_b16 a[88:89], v98 offset:32768
    ds_read_b64_tr_b16 a[90:91], v98 offset:36864
    ds_read_b64_tr_b16 a[92:93], v99 offset:32768
    ds_read_b64_tr_b16 a[94:95], v99 offset:36864
    ds_read_b64_tr_b16 a[96:97], v98 offset:49152
    ds_read_b64_tr_b16 a[98:99], v98 offset:53248
    ds_read_b64_tr_b16 a[100:101], v99 offset:49152
    ds_read_b64_tr_b16 a[102:103], v99 offset:53248
    ds_read_b64_tr_b16 a[104:105], v100 offset:0
    ds_read_b64_tr_b16 a[106:107], v100 offset:4096
    ds_read_b64_tr_b16 a[108:109], v101 offset:0
    ds_read_b64_tr_b16 a[110:111], v101 offset:4096
    ds_read_b64_tr_b16 a[112:113], v98 offset:0
    ds_read_b64_tr_b16 a[114:115], v98 offset:4096
    ds_read_b64_tr_b16 a[116:117], v99 offset:0
    ds_read_b64_tr_b16 a[118:119], v99 offset:4096
    ds_read_b64_tr_b16 a[120:121], v98 offset:16384
    ds_read_b64_tr_b16 a[122:123], v98 offset:20480
    ds_read_b64_tr_b16 a[124:125], v99 offset:16384
    ds_read_b64_tr_b16 a[126:127], v99 offset:20480
    s_add_u32 m0, s91, 114688
    s_add_u32 s93, s69, 2
    s_and_b32 s93, s93, 3
    s_lshl_b32 s89, s93, 15
    s_add_u32 s89, s89, s90
    buffer_load_dwordx4 v4, s[40:43], s89 offen offset:0 sc1 lds
    buffer_load_dwordx4 v4, s[40:43], s89 offen offset:1024 sc1 lds
    s_add_u32 m0, s92, 114688
    s_add_u32 s89, s89, 2048
    buffer_load_dwordx4 v4, s[40:43], s89 offen offset:0 sc1 lds
    buffer_load_dwordx4 v4, s[40:43], s89 offen offset:1024 sc1 lds
    s_cmp_lg_u32 s64, 5
    s_cbranch_scc1 L_p2pre
    s_waitcnt lgkmcnt(0)
    s_mov_b32 s76, s95
    s_mov_b32 s77, s95
    s_xor_b64 s[20:21], s[20:21], s[76:77]
    s_xor_b64 s[22:23], s[22:23], s[76:77]
    s_or_b64 s[20:21], s[20:21], s[22:23]
    s_xor_b64 s[24:25], s[24:25], s[76:77]
    s_or_b64 s[20:21], s[20:21], s[24:25]
    s_xor_b64 s[26:27], s[26:27], s[76:77]
    s_or_b64 s[20:21], s[20:21], s[26:27]
    s_cbranch_scc0 L_p2pre
    s_mov_b32 s75, 0
L_pollb:
    s_load_dwordx8 s[20:27], s[44:45], 128 glc
    s_add_u32 s75, s75, 1
    s_cmp_gt_u32 s75, 65536
    s_waitcnt lgkmcnt(0)
    s_cbranch_scc1 L_polledb
    s_mov_b32 s76, s95
    s_mov_b32 s77, s95
    s_xor_b64 s[20:21], s[20:21], s[76:77]
    s_xor_b64 s[22:23], s[22:23], s[76:77]
    s_or_b64 s[20:21], s[20:21], s[22:23]
    s_xor_b64 s[24:25], s[24:25], s[76:77]
    s_or_b64 s[20:21], s[20:21], s[24:25]
    s_xor_b64 s[26:27], s[26:27], s[76:77]
    s_or_b64 s[20:21], s[20:21], s[26:27]
    s_cbranch_scc1 L_pollb
L_polledb:
    s_branch L_p2pre
L_wo_ld:
    s_mov_b32 s72, 8
L_wo4:
    s_lshl_b32 s74, s72, 2
    s_lshr_b64 s[76:77], s[58:59], s74
    s_and_b32 s76, s76, 15
    s_lshl_b32 s76, s76, 14
    s_add_u32 s76, s76, s86
    s_add_u32 s74, s72, s83
    s_and_b32 s74, s74, 15
    s_lshl_b32 s74, s74, 16
    s_mov_b32 m0, s76
    s_add_u32 s74, s74, s87
    buffer_load_dwordx4 v15, s[36:39], s74 offen offset:0 lds
    buffer_load_dwordx4 v16, s[36:39], s74 offen offset:1024 lds
    buffer_load_dwordx4 v17, s[36:39], s74 offen offset:2048 lds
    buffer_load_dwordx4 v18, s[36:39], s74 offen offset:3072 lds
    s_add_u32 m0, s76, 4096
    s_add_u32 s74, s74, 32768
    buffer_load_dwordx4 v15, s[36:39], s74 offen offset:0 lds
    buffer_load_dwordx4 v16, s[36:39], s74 offen offset:1024 lds
    buffer_load_dwordx4 v17, s[36:39], s74 offen offset:2048 lds
    buffer_load_dwordx4 v18, s[36:39], s74 offen offset:3072 lds
    s_add_u32 s72, s72, 1
    s_cmp_lt_u32 s72, 10
    s_cbranch_scc1 L_wo4
    ds_read_b64_tr_b16 a[0:1], v102 offset:16384
    ds_read_b64_tr_b16 a[2:3], v102 offset:20480
    ds_read_b64_tr_b16 a[4:5], v103 offset:16384
    ds_read_b64_tr_b16 a[6:7], v103 offset:20480
    ds_read_b64_tr_b16 a[8:9], v98 offset:32768
    ds_read_b64_tr_b16 a[10:11], v98 offset:36864
    ds_read_b64_tr_b16 a[12:13], v99 offset:32768
    ds_read_b64_tr_b16 a[14:15], v99 offset:36864
    ds_read_b64_tr_b16 a[16:17], v98 offset:49152
    ds_read_b64_tr_b16 a[18:19], v98 offset:53248
    ds_read_b64_tr_b16 a[20:21], v99 offset:49152
    ds_read_b64_tr_b16 a[22:23], v99 offset:53248
    ds_read_b64_tr_b16 a[24:25], v100 offset:0
    ds_read_b64_tr_b16 a[26:27], v100 offset:4096
    ds_read_b64_tr_b16 a[28:29], v101 offset:0
    ds_read_b64_tr_b16 a[30:31], v101 offset:4096
    ds_read_b64_tr_b16 a[32:33], v98 offset:0
    ds_read_b64_tr_b16 a[34:35], v98 offset:4096
    ds_read_b64_tr_b16 a[36:37], v99 offset:0
    ds_read_b64_tr_b16 a[38:39], v99 offset:4096
    ds_read_b64_tr_b16 a[40:41], v98 offset:16384
    ds_read_b64_tr_b16 a[42:43], v98 offset:20480
    ds_read_b64_tr_b16 a[44:45], v99 offset:16384
    ds_read_b64_tr_b16 a[46:47], v99 offset:20480
    s_waitcnt lgkmcnt(0)
    s_barrier
    s_mov_b32 s72, 10
L_wo5:
    s_lshl_b32 s74, s72, 2
    s_lshr_b64 s[76:77], s[58:59], s74
    s_and_b32 s76, s76, 15
    s_lshl_b32 s76, s76, 14
    s_add_u32 s76, s76, s86
    s_add_u32 s74, s72, s83
    s_and_b32 s74, s74, 15
    s_lshl_b32 s74, s74, 16
    s_mov_b32 m0, s76
    s_add_u32 s74, s74, s87
    buffer_load_dwordx4 v15, s[36:39], s74 offen offset:0 lds
    buffer_load_dwordx4 v16, s[36:39], s74 offen offset:1024 lds
    buffer_load_dwordx4 v17, s[36:39], s74 offen offset:2048 lds
    buffer_load_dwordx4 v18, s[36:39], s74 offen offset:3072 lds
    s_add_u32 m0, s76, 4096
    s_add_u32 s74, s74, 32768
    buffer_load_dwordx4 v15, s[36:39], s74 offen offset:0 lds
    buffer_load_dwordx4 v16, s[36:39], s74 offen offset:1024 lds
    buffer_load_dwordx4 v17, s[36:39], s74 offen offset:2048 lds
    buffer_load_dwordx4 v18, s[36:39], s74 offen offset:3072 lds
    s_add_u32 s72, s72, 1
    s_cmp_lt_u32 s72, 12
    s_cbranch_scc1 L_wo5
    s_waitcnt vmcnt(16)
    s_barrier
    ds_read_b64_tr_b16 a[48:49], v100 offset:16384
    ds_read_b64_tr_b16 a[50:51], v100 offset:20480
    ds_read_b64_tr_b16 a[52:53], v101 offset:16384
    ds_read_b64_tr_b16 a[54:55], v101 offset:20480
    ds_read_b64_tr_b16 a[56:57], v100 offset:32768
    ds_read_b64_tr_b16 a[58:59], v100 offset:36864
    ds_read_b64_tr_b16 a[60:61], v101 offset:32768
    ds_read_b64_tr_b16 a[62:63], v101 offset:36864
    ds_read_b64_tr_b16 a[64:65], v100 offset:49152
    ds_read_b64_tr_b16 a[66:67], v100 offset:53248
    ds_read_b64_tr_b16 a[68:69], v101 offset:49152
    ds_read_b64_tr_b16 a[70:71], v101 offset:53248
    ds_read_b64_tr_b16 a[72:73], v102 offset:0
    ds_read_b64_tr_b16 a[74:75], v102 offset:4096
    ds_read_b64_tr_b16 a[76:77], v103 offset:0
    ds_read_b64_tr_b16 a[78:79], v103 offset:4096
    s_mov_b32 s72, 12
L_wo6:
    s_lshl_b32 s74, s72, 2
    s_lshr_b64 s[76:77], s[58:59], s74
    s_and_b32 s76, s76, 15
    s_lshl_b32 s76, s76, 14
    s_add_u32 s76, s76, s86
    s_add_u32 s74, s72, s83
    s_and_b32 s74, s74, 15
    s_lshl_b32 s74, s74, 16
    s_mov_b32 m0, s76
    s_add_u32 s74, s74, s87
    buffer_load_dwordx4 v15, s[36:39], s74 offen offset:0 lds
    buffer_load_dwordx4 v16, s[36:39], s74 offen offset:1024 lds
    buffer_load_dwordx4 v17, s[36:39], s74 offen offset:2048 lds
    buffer_load_dwordx4 v18, s[36:39], s74 offen offset:3072 lds
    s_add_u32 m0, s76, 4096
    s_add_u32 s74, s74, 32768
    buffer_load_dwordx4 v15, s[36:39], s74 offen offset:0 lds
    buffer_load_dwordx4 v16, s[36:39], s74 offen offset:1024 lds
    buffer_load_dwordx4 v17, s[36:39], s74 offen offset:2048 lds
    buffer_load_dwordx4 v18, s[36:39], s74 offen offset:3072 lds
    s_add_u32 s72, s72, 1
    s_cmp_lt_u32 s72, 15
    s_cbranch_scc1 L_wo6
    s_mov_b32 s72, 15
L_wo7:
    s_lshl_b32 s74, s72, 2
    s_lshr_b64 s[76:77], s[58:59], s74
    s_and_b32 s76, s76, 15
    s_lshl_b32 s76, s76, 14
    s_add_u32 s76, s76, s86
    s_add_u32 s74, s72, s83
    s_and_b32 s74, s74, 15
    s_lshl_b32 s74, s74, 16
    s_mov_b32 m0, s76
    s_add_u32 s74, s74, s87
    buffer_load_dwordx4 v15, s[36:39], s74 offen offset:0 lds
    buffer_load_dwordx4 v16, s[36:39], s74 offen offset:1024 lds
    buffer_load_dwordx4 v17, s[36:39], s74 offen offset:2048 lds
    buffer_load_dwordx4 v18, s[36:39], s74 offen offset:3072 lds
    s_add_u32 m0, s76, 4096
    s_add_u32 s74, s74, 32768
    buffer_load_dwordx4 v15, s[36:39], s74 offen offset:0 lds
    buffer_load_dwordx4 v16, s[36:39], s74 offen offset:1024 lds
    buffer_load_dwordx4 v17, s[36:39], s74 offen offset:2048 lds
    buffer_load_dwordx4 v18, s[36:39], s74 offen offset:3072 lds
    s_waitcnt lgkmcnt(0)
    s_barrier
    s_add_u32 s93, s69, 1
    s_and_b32 s93, s93, 3
    s_lshl_b32 s76, s86, 1
    s_lshl_b32 s77, s93, 15
    s_add_u32 s77, s77, s76
    s_add_u32 s76, s76, 81920
    s_lshl_b32 s75, s66, 14
    s_and_b32 s75, s75, 0x3fff
    s_lshl_b32 s78, s83, 10
    s_add_u32 s78, s78, s75
    s_mov_b32 s79, 8
L_oha:
    s_and_b32 s78, s78, 0x3fff
    s_add_u32 m0, s76, s75
    s_add_u32 s74, s77, s78
    buffer_load_dwordx4 v4, s[40:43], s74 offen sc1 lds
    buffer_load_dwordx4 v4, s[40:43], s74 offen offset:1024 sc1 lds
    s_add_u32 s78, s78, 2048
    s_add_u32 s75, s75, 2048
    s_and_b32 s75, s75, 0x3fff
    s_sub_u32 s79, s79, 1
    s_cmp_lg_u32 s79, 0
    s_cbranch_scc1 L_oha
    s_waitcnt vmcnt(16)
    s_barrier
    ds_read_b64_tr_b16 a[80:81], v102 offset:16384
    ds_read_b64_tr_b16 a[82:83], v102 offset:20480
    ds_read_b64_tr_b16 a[84:85], v103 offset:16384
    ds_read_b64_tr_b16 a[86:87], v103 offset:20480
    ds_read_b64_tr_b16 a[88:89], v98 offset:32768
    ds_read_b64_tr_b16 a[90:91], v98 offset:36864
    ds_read_b64_tr_b16 a[92:93], v99 offset:32768
    ds_read_b64_tr_b16 a[94:95], v99 offset:36864
    ds_read_b64_tr_b16 a[96:97], v98 offset:49152
    ds_read_b64_tr_b16 a[98:99], v98 offset:53248
    ds_read_b64_tr_b16 a[100:101], v99 offset:49152
    ds_read_b64_tr_b16 a[102:103], v99 offset:53248
    ds_read_b64_tr_b16 a[104:105], v100 offset:0
    ds_read_b64_tr_b16 a[106:107], v100 offset:4096
    ds_read_b64_tr_b16 a[108:109], v101 offset:0
    ds_read_b64_tr_b16 a[110:111], v101 offset:4096
    ds_read_b64_tr_b16 a[112:113], v98 offset:0
    ds_read_b64_tr_b16 a[114:115], v98 offset:4096
    ds_read_b64_tr_b16 a[116:117], v99 offset:0
    ds_read_b64_tr_b16 a[118:119], v99 offset:4096
    ds_read_b64_tr_b16 a[120:121], v98 offset:16384
    ds_read_b64_tr_b16 a[122:123], v98 offset:20480
    ds_read_b64_tr_b16 a[124:125], v99 offset:16384
    ds_read_b64_tr_b16 a[126:127], v99 offset:20480
    s_add_u32 m0, s91, 114688
    s_add_u32 s93, s69, 2
    s_and_b32 s93, s93, 3
    s_lshl_b32 s89, s93, 15
    s_add_u32 s89, s89, s90
    buffer_load_dwordx4 v4, s[40:43], s89 offen offset:0 sc1 lds
    buffer_load_dwordx4 v4, s[40:43], s89 offen offset:1024 sc1 lds
    s_add_u32 m0, s92, 114688
    s_add_u32 s89, s89, 2048
    buffer_load_dwordx4 v4, s[40:43], s89 offen offset:0 sc1 lds
    buffer_load_dwordx4 v4, s[40:43], s89 offen offset:1024 sc1 lds
    s_waitcnt vmcnt(4)
L_p2pre:
    s_waitcnt lgkmcnt(0)
    s_barrier
    s_cmp_eq_u32 s84, 1
    s_cbranch_scc1 L_p2b
    s_setprio 2
    v_mov_b32 v105, 0
    ds_write2_b32 v104, v105, v105 offset0:0 offset1:64
    ds_read_b128 v[16:19], v6 offset:0
    ds_read_b128 v[20:23], v6 offset:1024
    ds_read_b128 v[24:27], v6 offset:2048
    ds_read_b128 v[28:31], v6 offset:3072
    ds_read_b128 v[32:35], v6 offset:4096
    ds_read_b128 v[36:39], v6 offset:5120
    s_waitcnt lgkmcnt(5)
    v_mfma_f32_16x16x32_bf16 v[48:51], a[0:3], v[16:19], 0
    v_mfma_f32_16x16x32_bf16 v[52:55], a[4:7], v[16:19], 0
    s_add_u32 m0, s91, 0
    s_mov_b32 s93, 4
    s_lshl_b32 s89, s93, 15
    s_add_u32 s89, s89, s90
    buffer_load_dwordx4 v4, s[40:43], s89 offen offset:0 sc1 lds
    ds_read_b128 v[16:19], v6 offset:6144
    s_waitcnt lgkmcnt(5)
    v_mfma_f32_16x16x32_bf16 v[48:51], a[8:11], v[20:23], v[48:51]
    v_mfma_f32_16x16x32_bf16 v[52:55], a[12:15], v[20:23], v[52:55]
    ds_read_b128 v[20:23], v6 offset:7168
    s_waitcnt lgkmcnt(5)
    v_mfma_f32_16x16x32_bf16 v[48:51], a[16:19], v[24:27], v[48:51]
    v_mfma_f32_16x16x32_bf16 v[52:55], a[20:23], v[24:27], v[52:55]
    ds_read_b128 v[24:27], v6 offset:8192
    s_waitcnt lgkmcnt(5)
    v_mfma_f32_16x16x32_bf16 v[48:51], a[24:27], v[28:31], v[48:51]
    v_mfma_f32_16x16x32_bf16 v[52:55], a[28:31], v[28:31], v[52:55]
    buffer_load_dwordx4 v4, s[40:43], s89 offen offset:1024 sc1 lds
    ds_read_b128 v[28:31], v6 offset:9216
    s_waitcnt lgkmcnt(5)
    v_mfma_f32_16x16x32_bf16 v[48:51], a[32:35], v[32:35], v[48:51]
    v_mfma_f32_16x16x32_bf16 v[52:55], a[36:39], v[32:35], v[52:55]
    ds_read_b128 v[32:35], v6 offset:10240
    s_waitcnt lgkmcnt(5)
    v_mfma_f32_16x16x32_bf16 v[48:51], a[40:43], v[36:39], v[48:51]
    v_mfma_f32_16x16x32_bf16 v[52:55], a[44:47], v[36:39], v[52:55]
    ds_read_b128 v[36:39], v6 offset:11264
    s_waitcnt lgkmcnt(5)
    v_mfma_f32_16x16x32_bf16 v[48:51], a[48:51], v[16:19], v[48:51]
    v_mfma_f32_16x16x32_bf16 v[52:55], a[52:55], v[16:19], v[52:55]
    s_add_u32 m0, s92, 0
    s_add_u32 s89, s89, 2048
    buffer_load_dwordx4 v4, s[40:43], s89 offen offset:0 sc1 lds
    ds_read_b128 v[16:19], v6 offset:12288
    s_waitcnt lgkmcnt(5)
    v_mfma_f32_16x16x32_bf16 v[48:51], a[56:59], v[20:23], v[48:51]
    v_mfma_f32_16x16x32_bf16 v[52:55], a[60:63], v[20:23], v[52:55]
    ds_read_b128 v[20:23], v6 offset:13312
    s_waitcnt lgkmcnt(5)
    v_mfma_f32_16x16x32_bf16 v[48:51], a[64:67], v[24:27], v[48:51]
    v_mfma_f32_16x16x32_bf16 v[52:55], a[68:71], v[24:27], v[52:55]
    ds_read_b128 v[24:27], v6 offset:14336
    s_waitcnt lgkmcnt(5)
    v_mfma_f32_16x16x32_bf16 v[48:51], a[72:75], v[28:31], v[48:51]
    v_mfma_f32_16x16x32_bf16 v[52:55], a[76:79], v[28:31], v[52:55]
    buffer_load_dwordx4 v4, s[40:43], s89 offen offset:1024 sc1 lds
    ds_read_b128 v[28:31], v6 offset:15360
    s_waitcnt lgkmcnt(5)
    v_mfma_f32_16x16x32_bf16 v[48:51], a[80:83], v[32:35], v[48:51]
    v_mfma_f32_16x16x32_bf16 v[52:55], a[84:87], v[32:35], v[52:55]
    s_waitcnt vmcnt(4)
    s_barrier
    s_setprio 2
    ds_read_b128 v[32:35], v7 offset:0
    s_waitcnt lgkmcnt(5)
    v_mfma_f32_16x16x32_bf16 v[48:51], a[88:91], v[36:39], v[48:51]
    v_mfma_f32_16x16x32_bf16 v[52:55], a[92:95], v[36:39], v[52:55]
    ds_read_b128 v[36:39], v7 offset:1024
    s_waitcnt lgkmcnt(5)
    v_mfma_f32_16x16x32_bf16 v[48:51], a[96:99], v[16:19], v[48:51]
    v_mfma_f32_16x16x32_bf16 v[52:55], a[100:103], v[16:19], v[52:55]
    s_add_u32 m0, s91, 32768
    s_add_u32 s93, s69, 3
    s_and_b32 s93, s93, 3
    s_lshl_b32 s89, s93, 15
    s_add_u32 s89, s89, s90
    buffer_load_dwordx4 v4, s[40:43], s89 offen offset:0 sc1 lds
    ds_read_b128 v[16:19], v7 offset:2048
    s_waitcnt lgkmcnt(5)
    v_mfma_f32_16x16x32_bf16 v[48:51], a[104:107], v[20:23], v[48:51]
    v_mfma_f32_16x16x32_bf16 v[52:55], a[108:111], v[20:23], v[52:55]
    ds_read_b128 v[20:23], v7 offset:3072
    s_waitcnt lgkmcnt(5)
    v_mfma_f32_16x16x32_bf16 v[48:51], a[112:115], v[24:27], v[48:51]
    v_mfma_f32_16x16x32_bf16 v[52:55], a[116:119], v[24:27], v[52:55]
    ds_read_b128 v[24:27], v7 offset:4096
    s_waitcnt lgkmcnt(5)
    v_mfma_f32_16x16x32_bf16 v[48:51], a[120:123], v[28:31], v[48:51]
    v_mfma_f32_16x16x32_bf16 v[52:55], a[124:127], v[28:31], v[52:55]
    buffer_load_dwordx4 v4, s[40:43], s89 offen offset:1024 sc1 lds
    ds_read_b128 v[28:31], v7 offset:5120
    s_waitcnt lgkmcnt(5)
    v_mfma_f32_16x16x32_bf16 v[56:59], a[0:3], v[32:35], 0
    v_mfma_f32_16x16x32_bf16 v[60:63], a[4:7], v[32:35], 0
    s_setprio 0
    s_nop 4
    ds_write_b128 v10, v[48:51]
    ds_write_b128 v10, v[52:55] offset:1024
    v_mov_b32 v105, 1
    ds_write_b32 v104, v105 offset:0
    ds_read_b128 v[32:35], v7 offset:6144
    s_waitcnt lgkmcnt(8)
    v_mfma_f32_16x16x32_bf16 v[56:59], a[8:11], v[36:39], v[56:59]
    v_mfma_f32_16x16x32_bf16 v[60:63], a[12:15], v[36:39], v[60:63]
    ds_read_b128 v[36:39], v7 offset:7168
    s_waitcnt lgkmcnt(8)
    v_mfma_f32_16x16x32_bf16 v[56:59], a[16:19], v[16:19], v[56:59]
    v_mfma_f32_16x16x32_bf16 v[60:63], a[20:23], v[16:19], v[60:63]
    s_add_u32 m0, s92, 32768
    s_add_u32 s89, s89, 2048
    buffer_load_dwordx4 v4, s[40:43], s89 offen offset:0 sc1 lds
    ds_read_b128 v[16:19], v7 offset:8192
    s_waitcnt lgkmcnt(8)
    v_mfma_f32_16x16x32_bf16 v[56:59], a[24:27], v[20:23], v[56:59]
    v_mfma_f32_16x16x32_bf16 v[60:63], a[28:31], v[20:23], v[60:63]
    ds_read_b128 v[20:23], v7 offset:9216
    s_waitcnt lgkmcnt(8)
    v_mfma_f32_16x16x32_bf16 v[56:59], a[32:35], v[24:27], v[56:59]
    v_mfma_f32_16x16x32_bf16 v[60:63], a[36:39], v[24:27], v[60:63]
    ds_read_b128 v[24:27], v7 offset:10240
    s_waitcnt lgkmcnt(8)
    v_mfma_f32_16x16x32_bf16 v[56:59], a[40:43], v[28:31], v[56:59]
    v_mfma_f32_16x16x32_bf16 v[60:63], a[44:47], v[28:31], v[60:63]
    buffer_load_dwordx4 v4, s[40:43], s89 offen offset:1024 sc1 lds
    ds_read_b128 v[28:31], v7 offset:11264
    s_waitcnt lgkmcnt(5)
    v_mfma_f32_16x16x32_bf16 v[56:59], a[48:51], v[32:35], v[56:59]
    v_mfma_f32_16x16x32_bf16 v[60:63], a[52:55], v[32:35], v[60:63]
    ds_read_b128 v[32:35], v7 offset:12288
    s_waitcnt lgkmcnt(5)
    v_mfma_f32_16x16x32_bf16 v[56:59], a[56:59], v[36:39], v[56:59]
    v_mfma_f32_16x16x32_bf16 v[60:63], a[60:63], v[36:39], v[60:63]
    ds_read_b128 v[36:39], v7 offset:13312
    s_waitcnt lgkmcnt(5)
    v_mfma_f32_16x16x32_bf16 v[56:59], a[64:67], v[16:19], v[56:59]
    v_mfma_f32_16x16x32_bf16 v[60:63], a[68:71], v[16:19], v[60:63]
    ds_read_b128 v[16:19], v7 offset:14336
    s_waitcnt lgkmcnt(5)
    v_mfma_f32_16x16x32_bf16 v[56:59], a[72:75], v[20:23], v[56:59]
    v_mfma_f32_16x16x32_bf16 v[60:63], a[76:79], v[20:23], v[60:63]
    ds_read_b128 v[20:23], v7 offset:15360
    s_waitcnt lgkmcnt(5)
    v_mfma_f32_16x16x32_bf16 v[56:59], a[80:83], v[24:27], v[56:59]
    v_mfma_f32_16x16x32_bf16 v[60:63], a[84:87], v[24:27], v[60:63]
    s_waitcnt vmcnt(4)
    s_barrier
    s_setprio 2
    v_add_u32 v6, 0, v9
    ds_read_b128 v[24:27], v6 offset:0
    s_waitcnt lgkmcnt(5)
    v_mfma_f32_16x16x32_bf16 v[56:59], a[88:91], v[28:31], v[56:59]
    v_mfma_f32_16x16x32_bf16 v[60:63], a[92:95], v[28:31], v[60:63]
    s_add_u32 m0, s91, 81920
    s_add_u32 s93, s69, 4
    s_and_b32 s93, s93, 3
    s_lshl_b32 s89, s93, 15
    s_add_u32 s89, s89, s90
    buffer_load_dwordx4 v4, s[40:43], s89 offen offset:0 sc1 lds
    ds_read_b128 v[28:31], v6 offset:1024
    s_waitcnt lgkmcnt(5)
    v_mfma_f32_16x16x32_bf16 v[56:59], a[96:99], v[32:35], v[56:59]
    v_mfma_f32_16x16x32_bf16 v[60:63], a[100:103], v[32:35], v[60:63]
    ds_read_b128 v[32:35], v6 offset:2048
    s_waitcnt lgkmcnt(5)
    v_mfma_f32_16x16x32_bf16 v[56:59], a[104:107], v[36:39], v[56:59]
    v_mfma_f32_16x16x32_bf16 v[60:63], a[108:111], v[36:39], v[60:63]
    ds_read_b128 v[36:39], v6 offset:3072
    s_waitcnt lgkmcnt(5)
    v_mfma_f32_16x16x32_bf16 v[56:59], a[112:115], v[16:19], v[56:59]
    v_mfma_f32_16x16x32_bf16 v[60:63], a[116:119], v[16:19], v[60:63]
    buffer_load_dwordx4 v4, s[40:43], s89 offen offset:1024 sc1 lds
    ds_read_b128 v[16:19], v6 offset:4096
    s_waitcnt lgkmcnt(5)
    v_mfma_f32_16x16x32_bf16 v[56:59], a[120:123], v[20:23], v[56:59]
    v_mfma_f32_16x16x32_bf16 v[60:63], a[124:127], v[20:23], v[60:63]
    ds_read_b128 v[20:23], v6 offset:5120
    s_waitcnt lgkmcnt(5)
    v_mfma_f32_16x16x32_bf16 v[48:51], a[0:3], v[24:27], 0
    v_mfma_f32_16x16x32_bf16 v[52:55], a[4:7], v[24:27], 0
    s_setprio 0
    s_nop 4
    ds_write_b128 v11, v[56:59]
    ds_write_b128 v11, v[60:63] offset:1024
    v_mov_b32 v105, 2
    ds_write_b32 v104, v105 offset:0
    ds_read_b128 v[24:27], v6 offset:6144
    s_waitcnt lgkmcnt(8)
    v_mfma_f32_16x16x32_bf16 v[48:51], a[8:11], v[28:31], v[48:51]
    v_mfma_f32_16x16x32_bf16 v[52:55], a[12:15], v[28:31], v[52:55]
    s_add_u32 m0, s92, 81920
    s_add_u32 s89, s89, 2048
    buffer_load_dwordx4 v4, s[40:43], s89 offen offset:0 sc1 lds
    ds_read_b128 v[28:31], v6 offset:7168
    s_waitcnt lgkmcnt(8)
    v_mfma_f32_16x16x32_bf16 v[48:51], a[16:19], v[32:35], v[48:51]
    v_mfma_f32_16x16x32_bf16 v[52:55], a[20:23], v[32:35], v[52:55]
    ds_read_b128 v[32:35], v6 offset:8192
    s_waitcnt lgkmcnt(8)
    v_mfma_f32_16x16x32_bf16 v[48:51], a[24:27], v[36:39], v[48:51]
    v_mfma_f32_16x16x32_bf16 v[52:55], a[28:31], v[36:39], v[52:55]
    ds_read_b128 v[36:39], v6 offset:9216
    s_waitcnt lgkmcnt(8)
    v_mfma_f32_16x16x32_bf16 v[48:51], a[32:35], v[16:19], v[48:51]
    v_mfma_f32_16x16x32_bf16 v[52:55], a[36:39], v[16:19], v[52:55]
    buffer_load_dwordx4 v4, s[40:43], s89 offen offset:1024 sc1 lds
    ds_read_b128 v[16:19], v6 offset:10240
    s_waitcnt lgkmcnt(8)
    v_mfma_f32_16x16x32_bf16 v[48:51], a[40:43], v[20:23], v[48:51]
    v_mfma_f32_16x16x32_bf16 v[52:55], a[44:47], v[20:23], v[52:55]
    ds_read_b128 v[20:23], v6 offset:11264
    s_waitcnt lgkmcnt(5)
    v_mfma_f32_16x16x32_bf16 v[48:51], a[48:51], v[24:27], v[48:51]
    v_mfma_f32_16x16x32_bf16 v[52:55], a[52:55], v[24:27], v[52:55]
    ds_read_b128 v[24:27], v6 offset:12288
    s_waitcnt lgkmcnt(5)
    v_mfma_f32_16x16x32_bf16 v[48:51], a[56:59], v[28:31], v[48:51]
    v_mfma_f32_16x16x32_bf16 v[52:55], a[60:63], v[28:31], v[52:55]
    ds_read_b128 v[28:31], v6 offset:13312
    s_waitcnt lgkmcnt(5)
    v_mfma_f32_16x16x32_bf16 v[48:51], a[64:67], v[32:35], v[48:51]
    v_mfma_f32_16x16x32_bf16 v[52:55], a[68:71], v[32:35], v[52:55]
    ds_read_b128 v[32:35], v6 offset:14336
    s_waitcnt lgkmcnt(5)
    v_mfma_f32_16x16x32_bf16 v[48:51], a[72:75], v[36:39], v[48:51]
    v_mfma_f32_16x16x32_bf16 v[52:55], a[76:79], v[36:39], v[52:55]
    ds_read_b128 v[36:39], v6 offset:15360
    s_waitcnt lgkmcnt(5)
    v_mfma_f32_16x16x32_bf16 v[48:51], a[80:83], v[16:19], v[48:51]
    v_mfma_f32_16x16x32_bf16 v[52:55], a[84:87], v[16:19], v[52:55]
    s_waitcnt vmcnt(4)
    s_barrier
    s_setprio 2
    v_add_u32 v7, 32768, v9
    ds_read_b128 v[16:19], v7 offset:0
    s_waitcnt lgkmcnt(5)
    v_mfma_f32_16x16x32_bf16 v[48:51], a[88:91], v[20:23], v[48:51]
    v_mfma_f32_16x16x32_bf16 v[52:55], a[92:95], v[20:23], v[52:55]
    ds_read_b128 v[20:23], v7 offset:1024
    s_waitcnt lgkmcnt(5)
    v_mfma_f32_16x16x32_bf16 v[48:51], a[96:99], v[24:27], v[48:51]
    v_mfma_f32_16x16x32_bf16 v[52:55], a[100:103], v[24:27], v[52:55]
    ds_read_b128 v[24:27], v7 offset:2048
    s_waitcnt lgkmcnt(5)
    v_mfma_f32_16x16x32_bf16 v[48:51], a[104:107], v[28:31], v[48:51]
    v_mfma_f32_16x16x32_bf16 v[52:55], a[108:111], v[28:31], v[52:55]
    ds_read_b128 v[28:31], v7 offset:3072
    s_waitcnt lgkmcnt(5)
    v_mfma_f32_16x16x32_bf16 v[48:51], a[112:115], v[32:35], v[48:51]
    v_mfma_f32_16x16x32_bf16 v[52:55], a[116:119], v[32:35], v[52:55]
    ds_read_b128 v[32:35], v7 offset:4096
    s_waitcnt lgkmcnt(5)
    v_mfma_f32_16x16x32_bf16 v[48:51], a[120:123], v[36:39], v[48:51]
    v_mfma_f32_16x16x32_bf16 v[52:55], a[124:127], v[36:39], v[52:55]
    ds_read_b128 v[36:39], v7 offset:5120
    s_waitcnt lgkmcnt(5)
    v_mfma_f32_16x16x32_bf16 v[56:59], a[0:3], v[16:19], 0
    v_mfma_f32_16x16x32_bf16 v[60:63], a[4:7], v[16:19], 0
    s_setprio 0
    s_nop 4
    ds_write_b128 v10, v[48:51]
    ds_write_b128 v10, v[52:55] offset:1024
    v_mov_b32 v105, 3
    ds_write_b32 v104, v105 offset:0
    ds_read_b128 v[16:19], v7 offset:6144
    s_waitcnt lgkmcnt(8)
    v_mfma_f32_16x16x32_bf16 v[56:59], a[8:11], v[20:23], v[56:59]
    v_mfma_f32_16x16x32_bf16 v[60:63], a[12:15], v[20:23], v[60:63]
    ds_read_b128 v[20:23], v7 offset:7168
    s_waitcnt lgkmcnt(8)
    v_mfma_f32_16x16x32_bf16 v[56:59], a[16:19], v[24:27], v[56:59]
    v_mfma_f32_16x16x32_bf16 v[60:63], a[20:23], v[24:27], v[60:63]
    ds_read_b128 v[24:27], v7 offset:8192
    s_waitcnt lgkmcnt(8)
    v_mfma_f32_16x16x32_bf16 v[56:59], a[24:27], v[28:31], v[56:59]
    v_mfma_f32_16x16x32_bf16 v[60:63], a[28:31], v[28:31], v[60:63]
    ds_read_b128 v[28:31], v7 offset:9216
    s_waitcnt lgkmcnt(8)
    v_mfma_f32_16x16x32_bf16 v[56:59], a[32:35], v[32:35], v[56:59]
    v_mfma_f32_16x16x32_bf16 v[60:63], a[36:39], v[32:35], v[60:63]
    ds_read_b128 v[32:35], v7 offset:10240
    s_waitcnt lgkmcnt(8)
    v_mfma_f32_16x16x32_bf16 v[56:59], a[40:43], v[36:39], v[56:59]
    v_mfma_f32_16x16x32_bf16 v[60:63], a[44:47], v[36:39], v[60:63]
    ds_read_b128 v[36:39], v7 offset:11264
    s_waitcnt lgkmcnt(5)
    v_mfma_f32_16x16x32_bf16 v[56:59], a[48:51], v[16:19], v[56:59]
    v_mfma_f32_16x16x32_bf16 v[60:63], a[52:55], v[16:19], v[60:63]
    ds_read_b128 v[16:19], v7 offset:12288
    s_waitcnt lgkmcnt(5)
    v_mfma_f32_16x16x32_bf16 v[56:59], a[56:59], v[20:23], v[56:59]
    v_mfma_f32_16x16x32_bf16 v[60:63], a[60:63], v[20:23], v[60:63]
    ds_read_b128 v[20:23], v7 offset:13312
    s_waitcnt lgkmcnt(5)
    v_mfma_f32_16x16x32_bf16 v[56:59], a[64:67], v[24:27], v[56:59]
    v_mfma_f32_16x16x32_bf16 v[60:63], a[68:71], v[24:27], v[60:63]
    ds_read_b128 v[24:27], v7 offset:14336
    s_waitcnt lgkmcnt(5)
    v_mfma_f32_16x16x32_bf16 v[56:59], a[72:75], v[28:31], v[56:59]
    v_mfma_f32_16x16x32_bf16 v[60:63], a[76:79], v[28:31], v[60:63]
    ds_read_b128 v[28:31], v7 offset:15360
    s_waitcnt lgkmcnt(5)
    v_mfma_f32_16x16x32_bf16 v[56:59], a[80:83], v[32:35], v[56:59]
    v_mfma_f32_16x16x32_bf16 v[60:63], a[84:87], v[32:35], v[60:63]
    s_waitcnt vmcnt(0)
    s_barrier
    s_setprio 2
    v_add_u32 v6, 81920, v9
    ds_read_b128 v[32:35], v6 offset:0
    s_waitcnt lgkmcnt(5)
    v_mfma_f32_16x16x32_bf16 v[56:59], a[88:91], v[36:39], v[56:59]
    v_mfma_f32_16x16x32_bf16 v[60:63], a[92:95], v[36:39], v[60:63]
    ds_read_b128 v[36:39], v6 offset:1024
    s_waitcnt lgkmcnt(5)
    v_mfma_f32_16x16x32_bf16 v[56:59], a[96:99], v[16:19], v[56:59]
    v_mfma_f32_16x16x32_bf16 v[60:63], a[100:103], v[16:19], v[60:63]
    ds_read_b128 v[16:19], v6 offset:2048
    s_lshl_b32 s80, s85, 11
    s_add_u32 s80, s80, s94
    s_add_u32 s75, s80, 20480
    buffer_load_dwordx4 v[72:75], v4, s[48:51], s75 offen sc1
    buffer_load_dwordx4 v[76:79], v4, s[48:51], s75 offen offset:1024 sc1
    s_add_u32 s75, s80, 10240
    buffer_load_dwordx4 v[80:83], v4, s[48:51], s75 offen sc1
    buffer_load_dwordx4 v[84:87], v4, s[48:51], s75 offen offset:1024 sc1
    s_mul_i32 s81, s67, 5
    s_add_u32 s81, s81, s69
    s_lshl_b32 s81, s81, 15
    s_lshl_b32 s78, s70, 8
    s_add_u32 s81, s81, s78
    s_lshl_b32 s78, s85, 6
    s_add_u32 s81, s81, s78
    s_waitcnt lgkmcnt(5)
    v_mfma_f32_16x16x32_bf16 v[56:59], a[104:107], v[20:23], v[56:59]
    v_mfma_f32_16x16x32_bf16 v[60:63], a[108:111], v[20:23], v[60:63]
    ds_read_b128 v[20:23], v6 offset:3072
    s_waitcnt lgkmcnt(5)
    v_mfma_f32_16x16x32_bf16 v[56:59], a[112:115], v[24:27], v[56:59]
    v_mfma_f32_16x16x32_bf16 v[60:63], a[116:119], v[24:27], v[60:63]
    ds_read_b128 v[24:27], v6 offset:4096
    s_waitcnt lgkmcnt(5)
    v_mfma_f32_16x16x32_bf16 v[56:59], a[120:123], v[28:31], v[56:59]
    v_mfma_f32_16x16x32_bf16 v[60:63], a[124:127], v[28:31], v[60:63]
    ds_read_b128 v[28:31], v6 offset:5120
    s_waitcnt lgkmcnt(5)
    v_mfma_f32_16x16x32_bf16 v[48:51], a[0:3], v[32:35], 0
    v_mfma_f32_16x16x32_bf16 v[52:55], a[4:7], v[32:35], 0
    s_setprio 0
    s_nop 4
    ds_write_b128 v11, v[56:59]
    ds_write_b128 v11, v[60:63] offset:1024
    v_mov_b32 v105, 4
    ds_write_b32 v104, v105 offset:0
    ds_read_b128 v[32:35], v6 offset:6144
    s_waitcnt lgkmcnt(8)
    v_mfma_f32_16x16x32_bf16 v[48:51], a[8:11], v[36:39], v[48:51]
    v_mfma_f32_16x16x32_bf16 v[52:55], a[12:15], v[36:39], v[52:55]
    ds_read_b128 v[36:39], v6 offset:7168
    s_waitcnt lgkmcnt(8)
    v_mfma_f32_16x16x32_bf16 v[48:51], a[16:19], v[16:19], v[48:51]
    v_mfma_f32_16x16x32_bf16 v[52:55], a[20:23], v[16:19], v[52:55]
    ds_read_b128 v[16:19], v6 offset:8192
    s_waitcnt lgkmcnt(8)
    v_mfma_f32_16x16x32_bf16 v[48:51], a[24:27], v[20:23], v[48:51]
    v_mfma_f32_16x16x32_bf16 v[52:55], a[28:31], v[20:23], v[52:55]
    ds_read_b128 v[20:23], v6 offset:9216
    s_waitcnt lgkmcnt(8)
    v_mfma_f32_16x16x32_bf16 v[48:51], a[32:35], v[24:27], v[48:51]
    v_mfma_f32_16x16x32_bf16 v[52:55], a[36:39], v[24:27], v[52:55]
    ds_read_b128 v[24:27], v6 offset:10240
    s_waitcnt lgkmcnt(8)
    v_mfma_f32_16x16x32_bf16 v[48:51], a[40:43], v[28:31], v[48:51]
    v_mfma_f32_16x16x32_bf16 v[52:55], a[44:47], v[28:31], v[52:55]
    ds_read_b128 v[28:31], v6 offset:11264
    s_waitcnt lgkmcnt(5)
    v_mfma_f32_16x16x32_bf16 v[48:51], a[48:51], v[32:35], v[48:51]
    v_mfma_f32_16x16x32_bf16 v[52:55], a[52:55], v[32:35], v[52:55]
    ds_read_b128 v[32:35], v6 offset:12288
    s_waitcnt lgkmcnt(5)
    v_mfma_f32_16x16x32_bf16 v[48:51], a[56:59], v[36:39], v[48:51]
    v_mfma_f32_16x16x32_bf16 v[52:55], a[60:63], v[36:39], v[52:55]
    ds_read_b128 v[36:39], v6 offset:13312
    s_waitcnt lgkmcnt(5)
    v_mfma_f32_16x16x32_bf16 v[48:51], a[64:67], v[16:19], v[48:51]
    v_mfma_f32_16x16x32_bf16 v[52:55], a[68:71], v[16:19], v[52:55]
    ds_read_b128 v[16:19], v6 offset:14336
    s_waitcnt lgkmcnt(5)
    v_mfma_f32_16x16x32_bf16 v[48:51], a[72:75], v[20:23], v[48:51]
    v_mfma_f32_16x16x32_bf16 v[52:55], a[76:79], v[20:23], v[52:55]
    ds_read_b128 v[20:23], v6 offset:15360
    s_waitcnt lgkmcnt(5)
    v_mfma_f32_16x16x32_bf16 v[48:51], a[80:83], v[24:27], v[48:51]
    v_mfma_f32_16x16x32_bf16 v[52:55], a[84:87], v[24:27], v[52:55]
    s_waitcnt lgkmcnt(4)
    v_mfma_f32_16x16x32_bf16 v[48:51], a[88:91], v[28:31], v[48:51]
    v_mfma_f32_16x16x32_bf16 v[52:55], a[92:95], v[28:31], v[52:55]
    s_waitcnt lgkmcnt(3)
    v_mfma_f32_16x16x32_bf16 v[48:51], a[96:99], v[32:35], v[48:51]
    v_mfma_f32_16x16x32_bf16 v[52:55], a[100:103], v[32:35], v[52:55]
    s_waitcnt lgkmcnt(2)
    v_mfma_f32_16x16x32_bf16 v[48:51], a[104:107], v[36:39], v[48:51]
    v_mfma_f32_16x16x32_bf16 v[52:55], a[108:111], v[36:39], v[52:55]
    s_waitcnt lgkmcnt(1)
    v_mfma_f32_16x16x32_bf16 v[48:51], a[112:115], v[16:19], v[48:51]
    v_mfma_f32_16x16x32_bf16 v[52:55], a[116:119], v[16:19], v[52:55]
    s_waitcnt lgkmcnt(0)
    v_mfma_f32_16x16x32_bf16 v[48:51], a[120:123], v[20:23], v[48:51]
    v_mfma_f32_16x16x32_bf16 v[52:55], a[124:127], v[20:23], v[52:55]
    s_add_u32 s75, s80, 0
    buffer_load_dwordx4 v[88:91], v4, s[48:51], s75 offen sc1
    buffer_load_dwordx4 v[92:95], v4, s[48:51], s75 offen offset:1024 sc1
    s_waitcnt vmcnt(2)
    s_mov_b32 s79, 0
    s_branch L_chk_e
L_again_e:
    s_add_u32 s75, s80, 20480
    buffer_load_dwordx4 v[72:75], v4, s[48:51], s75 offen sc1
    buffer_load_dwordx4 v[76:79], v4, s[48:51], s75 offen offset:1024 sc1
    s_add_u32 s75, s80, 10240
    buffer_load_dwordx4 v[80:83], v4, s[48:51], s75 offen sc1
    buffer_load_dwordx4 v[84:87], v4, s[48:51], s75 offen offset:1024 sc1
    s_add_u32 s79, s79, 1
    s_waitcnt vmcnt(0)
L_chk_e:
    v_xor_b32 v72, v13, v72
    v_xor_b32 v73, v13, v73
    v_xor_b32 v74, v13, v74
    v_xor_b32 v75, v13, v75
    v_xor_b32 v76, v13, v76
    v_xor_b32 v77, v13, v77
    v_xor_b32 v78, v13, v78
    v_xor_b32 v79, v13, v79
    v_xor_b32 v80, v13, v80
    v_xor_b32 v81, v13, v81
    v_xor_b32 v82, v13, v82
    v_xor_b32 v83, v13, v83
    v_xor_b32 v84, v13, v84
    v_xor_b32 v85, v13, v85
    v_xor_b32 v86, v13, v86
    v_xor_b32 v87, v13, v87
    v_or3_b32 v14, v72, v73, v74
    v_or3_b32 v15, v75, v76, v77
    v_or3_b32 v14, v14, v78, v79
    v_or3_b32 v15, v15, v80, v81
    v_or3_b32 v14, v14, v82, v83
    v_or3_b32 v15, v15, v84, v85
    v_or3_b32 v14, v14, v86, v87
    v_or_b32 v14, v14, v15
    v_and_b32 v14, s56, v14
    v_cmp_ne_u32 vcc, 0, v14
    s_cmp_gt_u32 s79, 65536
    s_cbranch_scc1 L_got_e
    s_cbranch_vccnz L_again_e
L_got_e:
    v_add_f32 v64, v72, v80
    v_add_f32 v65, v73, v81
    v_add_f32 v66, v74, v82
    v_add_f32 v67, v75, v83
    v_add_f32 v68, v76, v84
    v_add_f32 v69, v77, v85
    v_add_f32 v70, v78, v86
    v_add_f32 v71, v79, v87
    ds_read_b32 v105, v104 offset:256
    ds_read_b128 v[16:19], v10
    ds_read_b128 v[20:23], v10 offset:1024
    s_nop 3
    v_add_f32 v48, v48, v64
    v_add_f32 v49, v49, v65
    v_add_f32 v50, v50, v66
    v_add_f32 v51, v51, v67
    v_add_f32 v52, v52, v68
    v_add_f32 v53, v53, v69
    v_add_f32 v54, v54, v70
    v_add_f32 v55, v55, v71
    s_waitcnt lgkmcnt(0)
    s_mov_b32 s79, 0
L_tk_a:
    v_readfirstlane_b32 s74, v105
    s_add_u32 s79, s79, 1
    s_cmp_ge_u32 s74, 5
    s_cbranch_scc1 L_tkd_a
    s_cmp_gt_u32 s79, 65536
    s_cbranch_scc1 L_tkd_a
    ds_read_b32 v105, v104 offset:256
    ds_read_b128 v[16:19], v10
    ds_read_b128 v[20:23], v10 offset:1024
    s_waitcnt lgkmcnt(0)
    s_branch L_tk_a
L_tkd_a:
    v_add_f32 v48, v48, v16
    v_add_f32 v49, v49, v17
    v_add_f32 v50, v50, v18
    v_add_f32 v51, v51, v19
    v_add_f32 v52, v52, v20
    v_add_f32 v53, v53, v21
    v_add_f32 v54, v54, v22
    v_add_f32 v55, v55, v23
    s_waitcnt vmcnt(0)
    s_mov_b32 s79, 0
    s_branch L_chk_a
L_again_a:
    s_add_u32 s75, s80, 0
    buffer_load_dwordx4 v[88:91], v4, s[48:51], s75 offen sc1
    buffer_load_dwordx4 v[92:95], v4, s[48:51], s75 offen offset:1024 sc1
    s_add_u32 s79, s79, 1
    s_waitcnt vmcnt(0)
L_chk_a:
    v_xor_b32 v88, v13, v88
    v_xor_b32 v89, v13, v89
    v_xor_b32 v90, v13, v90
    v_xor_b32 v91, v13, v91
    v_xor_b32 v92, v13, v92
    v_xor_b32 v93, v13, v93
    v_xor_b32 v94, v13, v94
    v_xor_b32 v95, v13, v95
    v_or3_b32 v14, v88, v89, v90
    v_or3_b32 v15, v91, v92, v93
    v_or3_b32 v14, v14, v94, v95
    v_or_b32 v14, v14, v15
    v_and_b32 v14, s56, v14
    v_cmp_ne_u32 vcc, 0, v14
    s_cmp_gt_u32 s79, 65536
    s_cbranch_scc1 L_got_a
    s_cbranch_vccnz L_again_a
L_got_a:
    v_add_f32 v48, v48, v88
    v_add_f32 v49, v49, v89
    v_add_f32 v50, v50, v90
    v_add_f32 v51, v51, v91
    v_add_f32 v52, v52, v92
    v_add_f32 v53, v53, v93
    v_add_f32 v54, v54, v94
    v_add_f32 v55, v55, v95
    v_cvt_pk_bf16_f32 v16, v48, v49
    v_cvt_pk_bf16_f32 v17, v50, v51
    v_cvt_pk_bf16_f32 v18, v52, v53
    v_cvt_pk_bf16_f32 v19, v54, v55
    s_nop 0
    v_permlane16_swap_b32 v16, v18
    v_permlane16_swap_b32 v17, v19
    buffer_store_dwordx4 v[16:19], v8, s[52:55], s81 offen
    s_and_b32 s74, s2, 31
    s_or_b32 s74, s74, s85
    s_cmp_lg_u32 s74, 0
    s_cbranch_scc1 L_done
    s_lshl_b32 s74, s67, 7
    s_add_u32 s74, s74, 7864320
    v_mov_b32 v24, s95
    v_mov_b32 v25, 0
    s_mov_b64 exec, 1
    buffer_store_dword v24, v25, s[48:51], s74 offen sc1
    s_mov_b64 exec, -1
    s_branch L_done
L_p2b:
    s_setprio 1
    ds_read_b128 v[16:19], v6 offset:0
    ds_read_b128 v[20:23], v6 offset:1024
    ds_read_b128 v[24:27], v6 offset:2048
    ds_read_b128 v[28:31], v6 offset:3072
    ds_read_b128 v[32:35], v6 offset:4096
    ds_read_b128 v[36:39], v6 offset:5120
    s_waitcnt lgkmcnt(5)
    v_mfma_f32_16x16x32_bf16 v[48:51], a[0:3], v[16:19], 0
    v_mfma_f32_16x16x32_bf16 v[52:55], a[4:7], v[16:19], 0
    s_add_u32 m0, s91, 0
    s_mov_b32 s93, 4
    s_lshl_b32 s89, s93, 15
    s_add_u32 s89, s89, s90
    buffer_load_dwordx4 v4, s[40:43], s89 offen offset:0 sc1 lds
    ds_read_b128 v[16:19], v6 offset:6144
    s_waitcnt lgkmcnt(5)
    v_mfma_f32_16x16x32_bf16 v[48:51], a[8:11], v[20:23], v[48:51]
    v_mfma_f32_16x16x32_bf16 v[52:55], a[12:15], v[20:23], v[52:55]
    ds_read_b128 v[20:23], v6 offset:7168
    s_waitcnt lgkmcnt(5)
    v_mfma_f32_16x16x32_bf16 v[48:51], a[16:19], v[24:27], v[48:51]
    v_mfma_f32_16x16x32_bf16 v[52:55], a[20:23], v[24:27], v[52:55]
    ds_read_b128 v[24:27], v6 offset:8192
    s_waitcnt lgkmcnt(5)
    v_mfma_f32_16x16x32_bf16 v[48:51], a[24:27], v[28:31], v[48:51]
    v_mfma_f32_16x16x32_bf16 v[52:55], a[28:31], v[28:31], v[52:55]
    buffer_load_dwordx4 v4, s[40:43], s89 offen offset:1024 sc1 lds
    ds_read_b128 v[28:31], v6 offset:9216
    s_waitcnt lgkmcnt(5)
    v_mfma_f32_16x16x32_bf16 v[48:51], a[32:35], v[32:35], v[48:51]
    v_mfma_f32_16x16x32_bf16 v[52:55], a[36:39], v[32:35], v[52:55]
    ds_read_b128 v[32:35], v6 offset:10240
    s_waitcnt lgkmcnt(5)
    v_mfma_f32_16x16x32_bf16 v[48:51], a[40:43], v[36:39], v[48:51]
    v_mfma_f32_16x16x32_bf16 v[52:55], a[44:47], v[36:39], v[52:55]
    ds_read_b128 v[36:39], v6 offset:11264
    s_waitcnt lgkmcnt(5)
    v_mfma_f32_16x16x32_bf16 v[48:51], a[48:51], v[16:19], v[48:51]
    v_mfma_f32_16x16x32_bf16 v[52:55], a[52:55], v[16:19], v[52:55]
    s_add_u32 m0, s92, 0
    s_add_u32 s89, s89, 2048
    buffer_load_dwordx4 v4, s[40:43], s89 offen offset:0 sc1 lds
    ds_read_b128 v[16:19], v6 offset:12288
    s_waitcnt lgkmcnt(5)
    v_mfma_f32_16x16x32_bf16 v[48:51], a[56:59], v[20:23], v[48:51]
    v_mfma_f32_16x16x32_bf16 v[52:55], a[60:63], v[20:23], v[52:55]
    ds_read_b128 v[20:23], v6 offset:13312
    s_waitcnt lgkmcnt(5)
    v_mfma_f32_16x16x32_bf16 v[48:51], a[64:67], v[24:27], v[48:51]
    v_mfma_f32_16x16x32_bf16 v[52:55], a[68:71], v[24:27], v[52:55]
    ds_read_b128 v[24:27], v6 offset:14336
    s_waitcnt lgkmcnt(5)
    v_mfma_f32_16x16x32_bf16 v[48:51], a[72:75], v[28:31], v[48:51]
    v_mfma_f32_16x16x32_bf16 v[52:55], a[76:79], v[28:31], v[52:55]
    buffer_load_dwordx4 v4, s[40:43], s89 offen offset:1024 sc1 lds
    ds_read_b128 v[28:31], v6 offset:15360
    s_waitcnt lgkmcnt(5)
    v_mfma_f32_16x16x32_bf16 v[48:51], a[80:83], v[32:35], v[48:51]
    v_mfma_f32_16x16x32_bf16 v[52:55], a[84:87], v[32:35], v[52:55]
    s_waitcnt vmcnt(4)
    s_barrier
    ds_read_b128 v[32:35], v7 offset:0
    s_waitcnt lgkmcnt(5)
    v_mfma_f32_16x16x32_bf16 v[48:51], a[88:91], v[36:39], v[48:51]
    v_mfma_f32_16x16x32_bf16 v[52:55], a[92:95], v[36:39], v[52:55]
    ds_read_b128 v[36:39], v7 offset:1024
    s_waitcnt lgkmcnt(5)
    v_mfma_f32_16x16x32_bf16 v[48:51], a[96:99], v[16:19], v[48:51]
    v_mfma_f32_16x16x32_bf16 v[52:55], a[100:103], v[16:19], v[52:55]
    s_add_u32 m0, s91, 32768
    s_add_u32 s93, s69, 3
    s_and_b32 s93, s93, 3
    s_lshl_b32 s89, s93, 15
    s_add_u32 s89, s89, s90
    buffer_load_dwordx4 v4, s[40:43], s89 offen offset:0 sc1 lds
    ds_read_b128 v[16:19], v7 offset:2048
    s_waitcnt lgkmcnt(5)
    v_mfma_f32_16x16x32_bf16 v[48:51], a[104:107], v[20:23], v[48:51]
    v_mfma_f32_16x16x32_bf16 v[52:55], a[108:111], v[20:23], v[52:55]
    ds_read_b128 v[20:23], v7 offset:3072
    s_waitcnt lgkmcnt(5)
    v_mfma_f32_16x16x32_bf16 v[48:51], a[112:115], v[24:27], v[48:51]
    v_mfma_f32_16x16x32_bf16 v[52:55], a[116:119], v[24:27], v[52:55]
    ds_read_b128 v[24:27], v7 offset:4096
    s_waitcnt lgkmcnt(5)
    v_mfma_f32_16x16x32_bf16 v[48:51], a[120:123], v[28:31], v[48:51]
    v_mfma_f32_16x16x32_bf16 v[52:55], a[124:127], v[28:31], v[52:55]
    buffer_load_dwordx4 v4, s[40:43], s89 offen offset:1024 sc1 lds
    ds_read_b128 v[28:31], v7 offset:5120
    s_waitcnt lgkmcnt(5)
    v_mfma_f32_16x16x32_bf16 v[56:59], a[0:3], v[32:35], 0
    v_mfma_f32_16x16x32_bf16 v[60:63], a[4:7], v[32:35], 0
    ds_read_b128 v[32:35], v7 offset:6144
    s_waitcnt lgkmcnt(5)
    v_mfma_f32_16x16x32_bf16 v[56:59], a[8:11], v[36:39], v[56:59]
    v_mfma_f32_16x16x32_bf16 v[60:63], a[12:15], v[36:39], v[60:63]
    ds_read_b32 v105, v104 offset:0
    ds_read_b128 v[72:75], v10
    ds_read_b128 v[76:79], v10 offset:1024
    ds_read_b128 v[36:39], v7 offset:7168
    s_waitcnt lgkmcnt(8)
    v_mfma_f32_16x16x32_bf16 v[56:59], a[16:19], v[16:19], v[56:59]
    v_mfma_f32_16x16x32_bf16 v[60:63], a[20:23], v[16:19], v[60:63]
    s_add_u32 m0, s92, 32768
    s_add_u32 s89, s89, 2048
    buffer_load_dwordx4 v4, s[40:43], s89 offen offset:0 sc1 lds
    ds_read_b128 v[16:19], v7 offset:8192
    s_waitcnt lgkmcnt(8)
    v_mfma_f32_16x16x32_bf16 v[56:59], a[24:27], v[20:23], v[56:59]
    v_mfma_f32_16x16x32_bf16 v[60:63], a[28:31], v[20:23], v[60:63]
    ds_read_b128 v[20:23], v7 offset:9216
    s_waitcnt lgkmcnt(3)
    s_mov_b32 s79, 0
L_tk_b1:
    v_readfirstlane_b32 s74, v105
    s_add_u32 s79, s79, 1
    s_cmp_ge_u32 s74, 1
    s_cbranch_scc1 L_tkd_b1
    s_cmp_gt_u32 s79, 65536
    s_cbranch_scc1 L_tkd_b1
    ds_read_b32 v105, v104 offset:0
    ds_read_b128 v[72:75], v10
    ds_read_b128 v[76:79], v10 offset:1024
    s_waitcnt lgkmcnt(0)
    s_branch L_tk_b1
L_tkd_b1:
    v_add_f32 v48, v48, v72
    v_add_f32 v49, v49, v73
    v_add_f32 v50, v50, v74
    v_add_f32 v51, v51, v75
    v_add_f32 v52, v52, v76
    v_add_f32 v53, v53, v77
    v_add_f32 v54, v54, v78
    v_add_f32 v55, v55, v79
    v_bfi_b32 v106, s56, v13, v48
    v_bfi_b32 v107, s56, v13, v49
    v_bfi_b32 v108, s56, v13, v50
    v_bfi_b32 v109, s56, v13, v51
    v_bfi_b32 v110, s56, v13, v52
    v_bfi_b32 v111, s56, v13, v53
    v_bfi_b32 v112, s56, v13, v54
    v_bfi_b32 v113, s56, v13, v55
    v_mfma_f32_16x16x32_bf16 v[56:59], a[32:35], v[24:27], v[56:59]
    v_mfma_f32_16x16x32_bf16 v[60:63], a[36:39], v[24:27], v[60:63]
    ds_read_b128 v[24:27], v7 offset:10240
    v_mfma_f32_16x16x32_bf16 v[56:59], a[40:43], v[28:31], v[56:59]
    v_mfma_f32_16x16x32_bf16 v[60:63], a[44:47], v[28:31], v[60:63]
    buffer_load_dwordx4 v4, s[40:43], s89 offen offset:1024 sc1 lds
    ds_read_b128 v[28:31], v7 offset:11264
    v_mfma_f32_16x16x32_bf16 v[56:59], a[48:51], v[32:35], v[56:59]
    v_mfma_f32_16x16x32_bf16 v[60:63], a[52:55], v[32:35], v[60:63]
    ds_read_b128 v[32:35], v7 offset:12288
    s_waitcnt lgkmcnt(5)
    v_mfma_f32_16x16x32_bf16 v[56:59], a[56:59], v[36:39], v[56:59]
    v_mfma_f32_16x16x32_bf16 v[60:63], a[60:63], v[36:39], v[60:63]
    ds_read_b128 v[36:39], v7 offset:13312
    s_waitcnt lgkmcnt(5)
    v_mfma_f32_16x16x32_bf16 v[56:59], a[64:67], v[16:19], v[56:59]
    v_mfma_f32_16x16x32_bf16 v[60:63], a[68:71], v[16:19], v[60:63]
    ds_read_b128 v[16:19], v7 offset:14336
    s_waitcnt lgkmcnt(5)
    v_mfma_f32_16x16x32_bf16 v[56:59], a[72:75], v[20:23], v[56:59]
    v_mfma_f32_16x16x32_bf16 v[60:63], a[76:79], v[20:23], v[60:63]
    ds_read_b128 v[20:23], v7 offset:15360
    s_waitcnt lgkmcnt(5)
    v_mfma_f32_16x16x32_bf16 v[56:59], a[80:83], v[24:27], v[56:59]
    v_mfma_f32_16x16x32_bf16 v[60:63], a[84:87], v[24:27], v[60:63]
    s_waitcnt vmcnt(4)
    s_barrier
    v_add_u32 v6, 0, v9
    ds_read_b128 v[24:27], v6 offset:0
    s_add_u32 s75, s69, 1
    s_and_b32 s75, s75, 3
    s_lshl_b32 s75, s75, 1
    s_and_b32 s74, s2, 0xf9
    s_or_b32 s74, s74, s75
    s_mul_i32 s74, s74, 30720
    s_lshl_b32 s75, s85, 11
    s_add_u32 s74, s74, s75
    s_add_u32 s74, s74, 20480
    buffer_store_dwordx4 v[106:109], v4, s[48:51], s74 offen sc1
    buffer_store_dwordx4 v[110:113], v4, s[48:51], s74 offen offset:1024 sc1
    s_waitcnt lgkmcnt(5)
    v_mfma_f32_16x16x32_bf16 v[56:59], a[88:91], v[28:31], v[56:59]
    v_mfma_f32_16x16x32_bf16 v[60:63], a[92:95], v[28:31], v[60:63]
    s_add_u32 m0, s91, 81920
    s_add_u32 s93, s69, 4
    s_and_b32 s93, s93, 3
    s_lshl_b32 s89, s93, 15
    s_add_u32 s89, s89, s90
    buffer_load_dwordx4 v4, s[40:43], s89 offen offset:0 sc1 lds
    ds_read_b128 v[28:31], v6 offset:1024
    s_waitcnt lgkmcnt(5)
    v_mfma_f32_16x16x32_bf16 v[56:59], a[96:99], v[32:35], v[56:59]
    v_mfma_f32_16x16x32_bf16 v[60:63], a[100:103], v[32:35], v[60:63]
    ds_read_b128 v[32:35], v6 offset:2048
    s_waitcnt lgkmcnt(5)
    v_mfma_f32_16x16x32_bf16 v[56:59], a[104:107], v[36:39], v[56:59]
    v_mfma_f32_16x16x32_bf16 v[60:63], a[108:111], v[36:39], v[60:63]
    ds_read_b128 v[36:39], v6 offset:3072
    s_waitcnt lgkmcnt(5)
    v_mfma_f32_16x16x32_bf16 v[56:59], a[112:115], v[16:19], v[56:59]
    v_mfma_f32_16x16x32_bf16 v[60:63], a[116:119], v[16:19], v[60:63]
    buffer_load_dwordx4 v4, s[40:43], s89 offen offset:1024 sc1 lds
    ds_read_b128 v[16:19], v6 offset:4096
    s_waitcnt lgkmcnt(5)
    v_mfma_f32_16x16x32_bf16 v[56:59], a[120:123], v[20:23], v[56:59]
    v_mfma_f32_16x16x32_bf16 v[60:63], a[124:127], v[20:23], v[60:63]
    ds_read_b128 v[20:23], v6 offset:5120
    s_waitcnt lgkmcnt(5)
    v_mfma_f32_16x16x32_bf16 v[48:51], a[0:3], v[24:27], 0
    v_mfma_f32_16x16x32_bf16 v[52:55], a[4:7], v[24:27], 0
    ds_read_b128 v[24:27], v6 offset:6144
    s_waitcnt lgkmcnt(5)
    v_mfma_f32_16x16x32_bf16 v[48:51], a[8:11], v[28:31], v[48:51]
    v_mfma_f32_16x16x32_bf16 v[52:55], a[12:15], v[28:31], v[52:55]
    ds_read_b32 v105, v104 offset:0
    ds_read_b128 v[72:75], v11
    ds_read_b128 v[76:79], v11 offset:1024
    s_add_u32 m0, s92, 81920
    s_add_u32 s89, s89, 2048
    buffer_load_dwordx4 v4, s[40:43], s89 offen offset:0 sc1 lds
    ds_read_b128 v[28:31], v6 offset:7168
    s_waitcnt lgkmcnt(8)
    v_mfma_f32_16x16x32_bf16 v[48:51], a[16:19], v[32:35], v[48:51]
    v_mfma_f32_16x16x32_bf16 v[52:55], a[20:23], v[32:35], v[52:55]
    ds_read_b128 v[32:35], v6 offset:8192
    s_waitcnt lgkmcnt(8)
    v_mfma_f32_16x16x32_bf16 v[48:51], a[24:27], v[36:39], v[48:51]
    v_mfma_f32_16x16x32_bf16 v[52:55], a[28:31], v[36:39], v[52:55]
    ds_read_b128 v[36:39], v6 offset:9216
    s_waitcnt lgkmcnt(3)
    s_mov_b32 s79, 0
L_tk_b2:
    v_readfirstlane_b32 s74, v105
    s_add_u32 s79, s79, 1
    s_cmp_ge_u32 s74, 2
    s_cbranch_scc1 L_tkd_b2
    s_cmp_gt_u32 s79, 65536
    s_cbranch_scc1 L_tkd_b2
    ds_read_b32 v105, v104 offset:0
    ds_read_b128 v[72:75], v11
    ds_read_b128 v[76:79], v11 offset:1024
    s_waitcnt lgkmcnt(0)
    s_branch L_tk_b2
L_tkd_b2:
    v_add_f32 v56, v56, v72
    v_add_f32 v57, v57, v73
    v_add_f32 v58, v58, v74
    v_add_f32 v59, v59, v75
    v_add_f32 v60, v60, v76
    v_add_f32 v61, v61, v77
    v_add_f32 v62, v62, v78
    v_add_f32 v63, v63, v79
    v_bfi_b32 v114, s56, v13, v56
    v_bfi_b32 v115, s56, v13, v57
    v_bfi_b32 v116, s56, v13, v58
    v_bfi_b32 v117, s56, v13, v59
    v_bfi_b32 v118, s56, v13, v60
    v_bfi_b32 v119, s56, v13, v61
    v_bfi_b32 v120, s56, v13, v62
    v_bfi_b32 v121, s56, v13, v63
    v_mfma_f32_16x16x32_bf16 v[48:51], a[32:35], v[16:19], v[48:51]
    v_mfma_f32_16x16x32_bf16 v[52:55], a[36:39], v[16:19], v[52:55]
    buffer_load_dwordx4 v4, s[40:43], s89 offen offset:1024 sc1 lds
    ds_read_b128 v[16:19], v6 offset:10240
    v_mfma_f32_16x16x32_bf16 v[48:51], a[40:43], v[20:23], v[48:51]
    v_mfma_f32_16x16x32_bf16 v[52:55], a[44:47], v[20:23], v[52:55]
    ds_read_b128 v[20:23], v6 offset:11264
    v_mfma_f32_16x16x32_bf16 v[48:51], a[48:51], v[24:27], v[48:51]
    v_mfma_f32_16x16x32_bf16 v[52:55], a[52:55], v[24:27], v[52:55]
    ds_read_b128 v[24:27], v6 offset:12288
    s_waitcnt lgkmcnt(5)
    v_mfma_f32_16x16x32_bf16 v[48:51], a[56:59], v[28:31], v[48:51]
    v_mfma_f32_16x16x32_bf16 v[52:55], a[60:63], v[28:31], v[52:55]
    ds_read_b128 v[28:31], v6 offset:13312
    s_waitcnt lgkmcnt(5)
    v_mfma_f32_16x16x32_bf16 v[48:51], a[64:67], v[32:35], v[48:51]
    v_mfma_f32_16x16x32_bf16 v[52:55], a[68:71], v[32:35], v[52:55]
    ds_read_b128 v[32:35], v6 offset:14336
    s_waitcnt lgkmcnt(5)
    v_mfma_f32_16x16x32_bf16 v[48:51], a[72:75], v[36:39], v[48:51]
    v_mfma_f32_16x16x32_bf16 v[52:55], a[76:79], v[36:39], v[52:55]
    ds_read_b128 v[36:39], v6 offset:15360
    s_waitcnt lgkmcnt(5)
    v_mfma_f32_16x16x32_bf16 v[48:51], a[80:83], v[16:19], v[48:51]
    v_mfma_f32_16x16x32_bf16 v[52:55], a[84:87], v[16:19], v[52:55]
    s_waitcnt vmcnt(6)
    s_barrier
    v_add_u32 v7, 32768, v9
    ds_read_b128 v[16:19], v7 offset:0
    s_add_u32 s75, s69, 2
    s_and_b32 s75, s75, 3
    s_lshl_b32 s75, s75, 1
    s_and_b32 s74, s2, 0xf9
    s_or_b32 s74, s74, s75
    s_mul_i32 s74, s74, 30720
    s_lshl_b32 s75, s85, 11
    s_add_u32 s74, s74, s75
    s_add_u32 s74, s74, 10240
    buffer_store_dwordx4 v[114:117], v4, s[48:51], s74 offen sc1
    buffer_store_dwordx4 v[118:121], v4, s[48:51], s74 offen offset:1024 sc1
    s_waitcnt lgkmcnt(5)
    v_mfma_f32_16x16x32_bf16 v[48:51], a[88:91], v[20:23], v[48:51]
    v_mfma_f32_16x16x32_bf16 v[52:55], a[92:95], v[20:23], v[52:55]
    ds_read_b128 v[20:23], v7 offset:1024
    s_waitcnt lgkmcnt(5)
    v_mfma_f32_16x16x32_bf16 v[48:51], a[96:99], v[24:27], v[48:51]
    v_mfma_f32_16x16x32_bf16 v[52:55], a[100:103], v[24:27], v[52:55]
    ds_read_b128 v[24:27], v7 offset:2048
    s_waitcnt lgkmcnt(5)
    v_mfma_f32_16x16x32_bf16 v[48:51], a[104:107], v[28:31], v[48:51]
    v_mfma_f32_16x16x32_bf16 v[52:55], a[108:111], v[28:31], v[52:55]
    ds_read_b128 v[28:31], v7 offset:3072
    s_waitcnt lgkmcnt(5)
    v_mfma_f32_16x16x32_bf16 v[48:51], a[112:115], v[32:35], v[48:51]
    v_mfma_f32_16x16x32_bf16 v[52:55], a[116:119], v[32:35], v[52:55]
    ds_read_b128 v[32:35], v7 offset:4096
    s_waitcnt lgkmcnt(5)
    v_mfma_f32_16x16x32_bf16 v[48:51], a[120:123], v[36:39], v[48:51]
    v_mfma_f32_16x16x32_bf16 v[52:55], a[124:127], v[36:39], v[52:55]
    ds_read_b128 v[36:39], v7 offset:5120
    s_waitcnt lgkmcnt(5)
    v_mfma_f32_16x16x32_bf16 v[56:59], a[0:3], v[16:19], 0
    v_mfma_f32_16x16x32_bf16 v[60:63], a[4:7], v[16:19], 0
    ds_read_b128 v[16:19], v7 offset:6144
    s_waitcnt lgkmcnt(5)
    v_mfma_f32_16x16x32_bf16 v[56:59], a[8:11], v[20:23], v[56:59]
    v_mfma_f32_16x16x32_bf16 v[60:63], a[12:15], v[20:23], v[60:63]
    ds_read_b32 v105, v104 offset:0
    ds_read_b128 v[72:75], v10
    ds_read_b128 v[76:79], v10 offset:1024
    ds_read_b128 v[20:23], v7 offset:7168
    s_waitcnt lgkmcnt(8)
    v_mfma_f32_16x16x32_bf16 v[56:59], a[16:19], v[24:27], v[56:59]
    v_mfma_f32_16x16x32_bf16 v[60:63], a[20:23], v[24:27], v[60:63]
    ds_read_b128 v[24:27], v7 offset:8192
    s_waitcnt lgkmcnt(8)
    v_mfma_f32_16x16x32_bf16 v[56:59], a[24:27], v[28:31], v[56:59]
    v_mfma_f32_16x16x32_bf16 v[60:63], a[28:31], v[28:31], v[60:63]
    ds_read_b128 v[28:31], v7 offset:9216
    s_waitcnt lgkmcnt(3)
    s_mov_b32 s79, 0
L_tk_b3:
    v_readfirstlane_b32 s74, v105
    s_add_u32 s79, s79, 1
    s_cmp_ge_u32 s74, 3
    s_cbranch_scc1 L_tkd_b3
    s_cmp_gt_u32 s79, 65536
    s_cbranch_scc1 L_tkd_b3
    ds_read_b32 v105, v104 offset:0
    ds_read_b128 v[72:75], v10
    ds_read_b128 v[76:79], v10 offset:1024
    s_waitcnt lgkmcnt(0)
    s_branch L_tk_b3
L_tkd_b3:
    v_add_f32 v64, v48, v72
    v_add_f32 v65, v49, v73
    v_add_f32 v66, v50, v74
    v_add_f32 v67, v51, v75
    v_add_f32 v68, v52, v76
    v_add_f32 v69, v53, v77
    v_add_f32 v70, v54, v78
    v_add_f32 v71, v55, v79
    v_bfi_b32 v80, s56, v13, v64
    v_bfi_b32 v81, s56, v13, v65
    v_bfi_b32 v82, s56, v13, v66
    v_bfi_b32 v83, s56, v13, v67
    v_bfi_b32 v84, s56, v13, v68
    v_bfi_b32 v85, s56, v13, v69
    v_bfi_b32 v86, s56, v13, v70
    v_bfi_b32 v87, s56, v13, v71
    v_mfma_f32_16x16x32_bf16 v[56:59], a[32:35], v[32:35], v[56:59]
    v_mfma_f32_16x16x32_bf16 v[60:63], a[36:39], v[32:35], v[60:63]
    ds_read_b128 v[32:35], v7 offset:10240
    v_mfma_f32_16x16x32_bf16 v[56:59], a[40:43], v[36:39], v[56:59]
    v_mfma_f32_16x16x32_bf16 v[60:63], a[44:47], v[36:39], v[60:63]
    ds_read_b128 v[36:39], v7 offset:11264
    s_cmp_eq_u32 s85, s69
    s_cbranch_scc1 L_keep
    s_and_b32 s74, s2, 0xf9
    s_lshl_b32 s75, s85, 1
    s_or_b32 s74, s74, s75
    s_mul_i32 s74, s74, 30720
    s_sub_u32 s75, s69, s85
    s_sub_u32 s75, s75, 1
    s_and_b32 s75, s75, 3
    s_mul_i32 s75, s75, 10240
    s_add_u32 s74, s74, s75
    s_add_u32 s74, s74, 8192
    buffer_store_dwordx4 v[80:83], v4, s[48:51], s74 offen sc1
    buffer_store_dwordx4 v[84:87], v4, s[48:51], s74 offen offset:1024 sc1
L_keep:
    v_mfma_f32_16x16x32_bf16 v[56:59], a[48:51], v[16:19], v[56:59]
    v_mfma_f32_16x16x32_bf16 v[60:63], a[52:55], v[16:19], v[60:63]
    ds_read_b128 v[16:19], v7 offset:12288
    s_waitcnt lgkmcnt(5)
    v_mfma_f32_16x16x32_bf16 v[56:59], a[56:59], v[20:23], v[56:59]
    v_mfma_f32_16x16x32_bf16 v[60:63], a[60:63], v[20:23], v[60:63]
    ds_read_b128 v[20:23], v7 offset:13312
    s_waitcnt lgkmcnt(5)
    v_mfma_f32_16x16x32_bf16 v[56:59], a[64:67], v[24:27], v[56:59]
    v_mfma_f32_16x16x32_bf16 v[60:63], a[68:71], v[24:27], v[60:63]
    ds_read_b128 v[24:27], v7 offset:14336
    s_waitcnt lgkmcnt(5)
    v_mfma_f32_16x16x32_bf16 v[56:59], a[72:75], v[28:31], v[56:59]
    v_mfma_f32_16x16x32_bf16 v[60:63], a[76:79], v[28:31], v[60:63]
    ds_read_b128 v[28:31], v7 offset:15360
    s_waitcnt lgkmcnt(5)
    v_mfma_f32_16x16x32_bf16 v[56:59], a[80:83], v[32:35], v[56:59]
    v_mfma_f32_16x16x32_bf16 v[60:63], a[84:87], v[32:35], v[60:63]
    s_waitcnt vmcnt(2)
    s_barrier
    v_add_u32 v6, 81920, v9
    ds_read_b128 v[32:35], v6 offset:0
    s_waitcnt lgkmcnt(5)
    v_mfma_f32_16x16x32_bf16 v[56:59], a[88:91], v[36:39], v[56:59]
    v_mfma_f32_16x16x32_bf16 v[60:63], a[92:95], v[36:39], v[60:63]
    ds_read_b128 v[36:39], v6 offset:1024
    s_waitcnt lgkmcnt(5)
    v_mfma_f32_16x16x32_bf16 v[56:59], a[96:99], v[16:19], v[56:59]
    v_mfma_f32_16x16x32_bf16 v[60:63], a[100:103], v[16:19], v[60:63]
    ds_read_b128 v[16:19], v6 offset:2048
    s_waitcnt lgkmcnt(5)
    v_mfma_f32_16x16x32_bf16 v[56:59], a[104:107], v[20:23], v[56:59]
    v_mfma_f32_16x16x32_bf16 v[60:63], a[108:111], v[20:23], v[60:63]
    ds_read_b128 v[20:23], v6 offset:3072
    s_waitcnt lgkmcnt(5)
    v_mfma_f32_16x16x32_bf16 v[56:59], a[112:115], v[24:27], v[56:59]
    v_mfma_f32_16x16x32_bf16 v[60:63], a[116:119], v[24:27], v[60:63]
    ds_read_b128 v[24:27], v6 offset:4096
    s_waitcnt lgkmcnt(5)
    v_mfma_f32_16x16x32_bf16 v[56:59], a[120:123], v[28:31], v[56:59]
    v_mfma_f32_16x16x32_bf16 v[60:63], a[124:127], v[28:31], v[60:63]
    ds_read_b128 v[28:31], v6 offset:5120
    s_waitcnt lgkmcnt(5)
    v_mfma_f32_16x16x32_bf16 v[48:51], a[0:3], v[32:35], 0
    v_mfma_f32_16x16x32_bf16 v[52:55], a[4:7], v[32:35], 0
    ds_read_b128 v[32:35], v6 offset:6144
    s_waitcnt lgkmcnt(5)
    v_mfma_f32_16x16x32_bf16 v[48:51], a[8:11], v[36:39], v[48:51]
    v_mfma_f32_16x16x32_bf16 v[52:55], a[12:15], v[36:39], v[52:55]
    ds_read_b32 v105, v104 offset:0
    ds_read_b128 v[72:75], v11
    ds_read_b128 v[76:79], v11 offset:1024
    ds_read_b128 v[36:39], v6 offset:7168
    s_waitcnt lgkmcnt(8)
    v_mfma_f32_16x16x32_bf16 v[48:51], a[16:19], v[16:19], v[48:51]
    v_mfma_f32_16x16x32_bf16 v[52:55], a[20:23], v[16:19], v[52:55]
    ds_read_b128 v[16:19], v6 offset:8192
    s_waitcnt lgkmcnt(8)
    v_mfma_f32_16x16x32_bf16 v[48:51], a[24:27], v[20:23], v[48:51]
    v_mfma_f32_16x16x32_bf16 v[52:55], a[28:31], v[20:23], v[52:55]
    ds_read_b128 v[20:23], v6 offset:9216
    s_waitcnt lgkmcnt(3)
    s_mov_b32 s79, 0
L_tk_b4:
    v_readfirstlane_b32 s74, v105
    s_add_u32 s79, s79, 1
    s_cmp_ge_u32 s74, 4
    s_cbranch_scc1 L_tkd_b4
    s_cmp_gt_u32 s79, 65536
    s_cbranch_scc1 L_tkd_b4
    ds_read_b32 v105, v104 offset:0
    ds_read_b128 v[72:75], v11
    ds_read_b128 v[76:79], v11 offset:1024
    s_waitcnt lgkmcnt(0)
    s_branch L_tk_b4
L_tkd_b4:
    v_add_f32 v56, v56, v72
    v_add_f32 v57, v57, v73
    v_add_f32 v58, v58, v74
    v_add_f32 v59, v59, v75
    v_add_f32 v60, v60, v76
    v_add_f32 v61, v61, v77
    v_add_f32 v62, v62, v78
    v_add_f32 v63, v63, v79
    v_bfi_b32 v88, s56, v13, v56
    v_bfi_b32 v89, s56, v13, v57
    v_bfi_b32 v90, s56, v13, v58
    v_bfi_b32 v91, s56, v13, v59
    v_bfi_b32 v92, s56, v13, v60
    v_bfi_b32 v93, s56, v13, v61
    v_bfi_b32 v94, s56, v13, v62
    v_bfi_b32 v95, s56, v13, v63
    s_add_u32 s75, s69, 3
    s_and_b32 s75, s75, 3
    s_lshl_b32 s75, s75, 1
    s_and_b32 s74, s2, 0xf9
    s_or_b32 s74, s74, s75
    s_mul_i32 s74, s74, 30720
    s_lshl_b32 s75, s85, 11
    s_add_u32 s74, s74, s75
    s_add_u32 s74, s74, 0
    buffer_store_dwordx4 v[88:91], v4, s[48:51], s74 offen sc1
    buffer_store_dwordx4 v[92:95], v4, s[48:51], s74 offen offset:1024 sc1
    v_mfma_f32_16x16x32_bf16 v[48:51], a[32:35], v[24:27], v[48:51]
    v_mfma_f32_16x16x32_bf16 v[52:55], a[36:39], v[24:27], v[52:55]
    ds_read_b128 v[24:27], v6 offset:10240
    v_mfma_f32_16x16x32_bf16 v[48:51], a[40:43], v[28:31], v[48:51]
    v_mfma_f32_16x16x32_bf16 v[52:55], a[44:47], v[28:31], v[52:55]
    ds_read_b128 v[28:31], v6 offset:11264
    v_mfma_f32_16x16x32_bf16 v[48:51], a[48:51], v[32:35], v[48:51]
    v_mfma_f32_16x16x32_bf16 v[52:55], a[52:55], v[32:35], v[52:55]
    ds_read_b128 v[32:35], v6 offset:12288
    s_waitcnt lgkmcnt(5)
    v_mfma_f32_16x16x32_bf16 v[48:51], a[56:59], v[36:39], v[48:51]
    v_mfma_f32_16x16x32_bf16 v[52:55], a[60:63], v[36:39], v[52:55]
    ds_read_b128 v[36:39], v6 offset:13312
    s_waitcnt lgkmcnt(5)
    v_mfma_f32_16x16x32_bf16 v[48:51], a[64:67], v[16:19], v[48:51]
    v_mfma_f32_16x16x32_bf16 v[52:55], a[68:71], v[16:19], v[52:55]
    ds_read_b128 v[16:19], v6 offset:14336
    s_waitcnt lgkmcnt(5)
    v_mfma_f32_16x16x32_bf16 v[48:51], a[72:75], v[20:23], v[48:51]
    v_mfma_f32_16x16x32_bf16 v[52:55], a[76:79], v[20:23], v[52:55]
    ds_read_b128 v[20:23], v6 offset:15360
    s_waitcnt lgkmcnt(5)
    v_mfma_f32_16x16x32_bf16 v[48:51], a[80:83], v[24:27], v[48:51]
    v_mfma_f32_16x16x32_bf16 v[52:55], a[84:87], v[24:27], v[52:55]
    s_waitcnt lgkmcnt(4)
    v_mfma_f32_16x16x32_bf16 v[48:51], a[88:91], v[28:31], v[48:51]
    v_mfma_f32_16x16x32_bf16 v[52:55], a[92:95], v[28:31], v[52:55]
    s_waitcnt lgkmcnt(3)
    v_mfma_f32_16x16x32_bf16 v[48:51], a[96:99], v[32:35], v[48:51]
    v_mfma_f32_16x16x32_bf16 v[52:55], a[100:103], v[32:35], v[52:55]
    s_waitcnt lgkmcnt(2)
    v_mfma_f32_16x16x32_bf16 v[48:51], a[104:107], v[36:39], v[48:51]
    v_mfma_f32_16x16x32_bf16 v[52:55], a[108:111], v[36:39], v[52:55]
    s_waitcnt lgkmcnt(1)
    v_mfma_f32_16x16x32_bf16 v[48:51], a[112:115], v[16:19], v[48:51]
    v_mfma_f32_16x16x32_bf16 v[52:55], a[116:119], v[16:19], v[52:55]
    s_waitcnt lgkmcnt(0)
    v_mfma_f32_16x16x32_bf16 v[48:51], a[120:123], v[20:23], v[48:51]
    v_mfma_f32_16x16x32_bf16 v[52:55], a[124:127], v[20:23], v[52:55]
    s_nop 6
    ds_write_b128 v10, v[48:51]
    ds_write_b128 v10, v[52:55] offset:1024
    v_mov_b32 v105, 5
    ds_write_b32 v104, v105 offset:256
    s_cmp_lg_u32 s85, s69
    s_cbranch_scc1 L_done
    s_add_u32 s80, s94, 8192
    s_add_u32 s75, s80, 0
    buffer_load_dwordx4 v[16:19], v4, s[48:51], s75 offen sc1
    buffer_load_dwordx4 v[20:23], v4, s[48:51], s75 offen offset:1024 sc1
    s_add_u32 s75, s80, 10240
    buffer_load_dwordx4 v[24:27], v4, s[48:51], s75 offen sc1
    buffer_load_dwordx4 v[28:31], v4, s[48:51], s75 offen offset:1024 sc1
    s_add_u32 s75, s80, 20480
    buffer_load_dwordx4 v[32:35], v4, s[48:51], s75 offen sc1
    buffer_load_dwordx4 v[36:39], v4, s[48:51], s75 offen offset:1024 sc1
    s_mul_i32 s81, s67, 5
    s_add_u32 s81, s81, 4
    s_lshl_b32 s81, s81, 15
    s_lshl_b32 s78, s70, 8
    s_add_u32 s81, s81, s78
    s_lshl_b32 s78, s85, 6
    s_add_u32 s81, s81, s78
    s_waitcnt vmcnt(0)
    s_mov_b32 s79, 0
    s_branch L_chk_t4
L_again_t4:
    s_add_u32 s75, s80, 0
    buffer_load_dwordx4 v[16:19], v4, s[48:51], s75 offen sc1
    buffer_load_dwordx4 v[20:23], v4, s[48:51], s75 offen offset:1024 sc1
    s_add_u32 s75, s80, 10240
    buffer_load_dwordx4 v[24:27], v4, s[48:51], s75 offen sc1
    buffer_load_dwordx4 v[28:31], v4, s[48:51], s75 offen offset:1024 sc1
    s_add_u32 s75, s80, 20480
    buffer_load_dwordx4 v[32:35], v4, s[48:51], s75 offen sc1
    buffer_load_dwordx4 v[36:39], v4, s[48:51], s75 offen offset:1024 sc1
    s_add_u32 s79, s79, 1
    s_waitcnt vmcnt(0)
L_chk_t4:
    v_xor_b32 v16, v13, v16
    v_xor_b32 v17, v13, v17
    v_xor_b32 v18, v13, v18
    v_xor_b32 v19, v13, v19
    v_xor_b32 v20, v13, v20
    v_xor_b32 v21, v13, v21
    v_xor_b32 v22, v13, v22
    v_xor_b32 v23, v13, v23
    v_xor_b32 v24, v13, v24
    v_xor_b32 v25, v13, v25
    v_xor_b32 v26, v13, v26
    v_xor_b32 v27, v13, v27
    v_xor_b32 v28, v13, v28
    v_xor_b32 v29, v13, v29
    v_xor_b32 v30, v13, v30
    v_xor_b32 v31, v13, v31
    v_xor_b32 v32, v13, v32
    v_xor_b32 v33, v13, v33
    v_xor_b32 v34, v13, v34
    v_xor_b32 v35, v13, v35
    v_xor_b32 v36, v13, v36
    v_xor_b32 v37, v13, v37
    v_xor_b32 v38, v13, v38
    v_xor_b32 v39, v13, v39
    v_or3_b32 v14, v16, v17, v18
    v_or3_b32 v15, v19, v20, v21
    v_or3_b32 v14, v14, v22, v23
    v_or3_b32 v15, v15, v24, v25
    v_or3_b32 v14, v14, v26, v27
    v_or3_b32 v15, v15, v28, v29
    v_or3_b32 v14, v14, v30, v31
    v_or3_b32 v15, v15, v32, v33
    v_or3_b32 v14, v14, v34, v35
    v_or3_b32 v15, v15, v36, v37
    v_or3_b32 v14, v14, v38, v39
    v_or_b32 v14, v14, v15
    v_and_b32 v14, s56, v14
    v_cmp_ne_u32 vcc, 0, v14
    s_cmp_gt_u32 s79, 65536
    s_cbranch_scc1 L_got_t4
    s_cbranch_vccnz L_again_t4
L_got_t4:
    v_add_f32 v64, v64, v16
    v_add_f32 v65, v65, v17
    v_add_f32 v66, v66, v18
    v_add_f32 v67, v67, v19
    v_add_f32 v68, v68, v20
    v_add_f32 v69, v69, v21
    v_add_f32 v70, v70, v22
    v_add_f32 v71, v71, v23
    v_add_f32 v64, v64, v24
    v_add_f32 v65, v65, v25
    v_add_f32 v66, v66, v26
    v_add_f32 v67, v67, v27
    v_add_f32 v68, v68, v28
    v_add_f32 v69, v69, v29
    v_add_f32 v70, v70, v30
    v_add_f32 v71, v71, v31
    v_add_f32 v64, v64, v32
    v_add_f32 v65, v65, v33
    v_add_f32 v66, v66, v34
    v_add_f32 v67, v67, v35
    v_add_f32 v68, v68, v36
    v_add_f32 v69, v69, v37
    v_add_f32 v70, v70, v38
    v_add_f32 v71, v71, v39
    v_cvt_pk_bf16_f32 v16, v64, v65
    v_cvt_pk_bf16_f32 v17, v66, v67
    v_cvt_pk_bf16_f32 v18, v68, v69
    v_cvt_pk_bf16_f32 v19, v70, v71
    s_nop 0
    v_permlane16_swap_b32 v16, v18
    v_permlane16_swap_b32 v17, v19
    buffer_store_dwordx4 v[16:19], v8, s[52:55], s81 offen
L_done:
L_end:
    s_endpgm
.section .rodata,"a"
.p2align 6
.amdhsa_kernel standalone__mha_block_cached__near_ridge_kernel
.amdhsa_next_free_vgpr 256
.amdhsa_next_free_sgpr 102
.amdhsa_accum_offset 128
.amdhsa_group_segment_fixed_size 0
.amdhsa_kernarg_size 64
.amdhsa_user_sgpr_count 2
.amdhsa_user_sgpr_kernarg_segment_ptr 1
.amdhsa_system_sgpr_workgroup_id_x 1
.amdhsa_float_denorm_mode_32 3
.end_amdhsa_kernel
```
